```python
import torch

def _softmax(x, axis=-1):
    return torch.softmax(x, dim=axis)
def _gelu(x):
    return torch.nn.functional.gelu(x, approximate="tanh")
def _silu(x):
    return torch.nn.functional.silu(x)
def _sigmoid(x):
    return torch.sigmoid(x)
def _layernorm(x, axis=-1, eps=1e-5):
    m = x.mean(dim=axis, keepdim=True)
    v = x.var(dim=axis, keepdim=True, unbiased=False)
    return (x - m) / torch.sqrt(v + eps)
def _scatter_add(tgt, idx, src, axis=0):
    return tgt.clone().index_add_(axis, idx, src)
def _segment_sum(src, seg, n):
    out = torch.zeros((n,) + src.shape[1:], dtype=src.dtype)
    return out.index_add_(0, seg, src)
def _pad(x, pw):
    flat = tuple(v for pair in reversed(pw) for v in pair)
    return torch.nn.functional.pad(x, flat)

kernel_name = 'parallel_sum__ssm_conv_s4d__glu_gated_bilinear__prompt'

def setup_inputs():

    _w = (lambda a: (lambda t: t.to(torch.bfloat16) if t.is_floating_point() else t)(torch.as_tensor(a)))
    def _A_setup():
        Bsz, L, D, N = 1, 2048, 512, 128
        return {
            "u": _w((lambda *s: torch.randn(*s, dtype=torch.bfloat16) * 0.05)(Bsz, L, D)),
            "log_A_real": _w((lambda *s: torch.randn(*s, dtype=torch.bfloat16) * 3.2)(D, N) * 0.5),
            "A_imag": _w((lambda *s: torch.randn(*s, dtype=torch.bfloat16) * 0.05)(D, N) * 3.14),
            "C_real": _w((lambda *s: torch.randn(*s, dtype=torch.bfloat16) * 0.1)(D, N) / N ** 0.5),
            "C_imag": _w((lambda *s: torch.randn(*s, dtype=torch.bfloat16) * 0.2)(D, N) / N ** 0.5),
            "log_dt": _w((lambda *s: torch.randn(*s, dtype=torch.bfloat16) * 0.05)(D) * 0.5 - 4.0),
            "D_skip": _w((lambda *s: torch.randn(*s, dtype=torch.bfloat16) * 0.05)(D)),
        }
    _A_in = _A_setup()

    def _B_setup():
        B, S, D, F = 1, 2048, 512, 1376
        return {
            "x": _w((lambda *s: torch.randn(*s, dtype=torch.bfloat16) * 0.05)(B, S, D)),
            "w_gate": _w((lambda *s: torch.randn(*s, dtype=torch.bfloat16) * 0.4)(D, F) * (D ** -0.5)),
            "w_up": _w((lambda *s: torch.randn(*s, dtype=torch.bfloat16) * 0.4)(D, F) * (D ** -0.5)),
            "w_down": _w((lambda *s: torch.randn(*s, dtype=torch.bfloat16) * 0.4)(F, D) * (F ** -0.5)),
        }
    _B_in = _B_setup()

    return {
        "A_u": _A_in["u"],
        "A_log_A_real": _A_in["log_A_real"],
        "A_A_imag": _A_in["A_imag"],
        "A_C_real": _A_in["C_real"],
        "A_C_imag": _A_in["C_imag"],
        "A_log_dt": _A_in["log_dt"],
        "A_D_skip": _A_in["D_skip"],
        "B_x": _B_in["x"],
        "B_w_gate": _B_in["w_gate"],
        "B_w_up": _B_in["w_up"],
        "B_w_down": _B_in["w_down"],
    }

def reference(A_u, A_log_A_real, A_A_imag, A_C_real, A_C_imag, A_log_dt, A_D_skip, B_x, B_w_gate, B_w_up, B_w_down):
    def _A_ref(u, log_A_real, A_imag, C_real, C_imag, log_dt, D_skip):
        L = u.shape[1]
        dt = torch.exp(log_dt)
        A = -torch.exp(log_A_real) + 1j * A_imag
        C = (C_real + 1j * C_imag) * dt[:, None]
        pos = (lambda x, dt: x.to(dt))(torch.arange(L), log_dt.dtype)
        P = torch.exp((A * dt[:, None])[:, :, None] * pos[None, None, :])
        K = 2.0 * torch.einsum("dn,dnl->dl", C, P).real
        L2 = 2 * L
        u_t = (lambda x, *d: x.permute(*d))(u, 0, 2, 1)
        Kf = (lambda x, *a, **k: torch.fft.rfft(x.float(), *a, **k))(K, L2)
        Uf = (lambda x, *a, **k: torch.fft.rfft(x.float(), *a, **k))(u_t, L2)
        y = (lambda x, *a, **k: torch.fft.irfft(x, *a, **k).to(torch.bfloat16))(Uf * Kf[None, :, :], L2)[:, :, :L]
        y = (lambda x, *d: x.permute(*d))(y, 0, 2, 1)
        return y + u * D_skip[None, None, :]

    def _B_ref(x, w_gate, w_up, w_down):
        g = torch.einsum("bsd,df->bsf", x, w_gate)
        u = torch.einsum("bsd,df->bsf", x, w_up)
        h = g * u
        return torch.einsum("bsf,fd->bsd", h, w_down)

    x = A_u
    xn = _layernorm(x, axis=-1)
    return x + _A_ref(xn, A_log_A_real, A_A_imag, A_C_real, A_C_imag, A_log_dt, A_D_skip) + _B_ref(xn, B_w_gate, B_w_up, B_w_down)
```

```asm
; @launch grid=(512,1,1) block=(256,1,1) lds=81920
.amdgcn_target "amdgcn-amd-amdhsa--gfx950"
.text
.globl parallel_sum__ssm_conv_s4d__glu_gated_bilinear__prompt_kernel
.p2align 8
.type parallel_sum__ssm_conv_s4d__glu_gated_bilinear__prompt_kernel,@function
parallel_sum__ssm_conv_s4d__glu_gated_bilinear__prompt_kernel:
  s_load_dwordx16 s[8:23], s[0:1], 0
  s_load_dwordx8 s[24:31], s[0:1], 64
  s_load_dwordx4 s[32:35], s[0:1], 96
  v_lshrrev_b32 v1, 6, v0
  v_and_b32 v2, 63, v0
  v_readfirstlane_b32 s36, v1
  s_cmp_lt_u32 s2, 512
  s_cbranch_scc1 K_GO
  s_endpgm
K_GO:
  s_cmp_ge_u32 s2, 256
  s_cbranch_scc1 S_ROLE
  s_setprio 2
  s_sub_u32 s37, s2, 0
  s_and_b32 s42, s37, 7
  s_lshr_b32 s43, s37, 3
  s_and_b32 s40, s42, 1
  s_lshl_b32 s40, s40, 3
  s_and_b32 s44, s43, 7
  s_add_u32 s40, s40, s44
  s_lshr_b32 s41, s42, 1
  s_lshl_b32 s41, s41, 2
  s_lshr_b32 s44, s43, 3
  s_add_u32 s41, s41, s44
  s_lshl_b32 s45, s40, 7
  s_lshl_b32 s46, s36, 5
  s_add_u32 s45, s45, s46
  s_lshl_b32 s45, s45, 10
  v_bfe_u32 v20, v2, 2, 3
  v_lshl_add_u32 v20, v20, 12, s45
  v_lshrrev_b32 v21, 5, v2
  v_lshl_add_u32 v20, v21, 6, v20
  v_and_b32 v21, 3, v2
  v_lshl_add_u32 v6, v21, 4, v20
  s_mul_i32 s42, s41, 96
  s_min_u32 s42, s42, 1280
  s_and_b32 s43, s36, 1
  s_mul_i32 s43, s43, 22016
  s_lshl_b32 s44, s42, 1
  s_add_u32 s44, s44, s43
  v_mul_u32_u24 v21, 43691, v2
  v_lshrrev_b32 v21, 19, v21
  v_mul_u32_u24 v22, 12, v21
  v_sub_u32 v22, v2, v22
  v_lshrrev_b32 v23, 3, v21
  v_and_b32 v21, 7, v21
  v_lshl_add_u32 v21, v23, 5, v21
  v_mul_u32_u24 v21, 2752, v21
  v_lshl_add_u32 v21, v22, 4, v21
  v_add_u32 v3, s44, v21
  v_add_u32 v20, 64, v2
  v_mul_u32_u24 v21, 43691, v20
  v_lshrrev_b32 v21, 19, v21
  v_mul_u32_u24 v22, 12, v21
  v_sub_u32 v22, v20, v22
  v_lshrrev_b32 v23, 3, v21
  v_and_b32 v21, 7, v21
  v_lshl_add_u32 v21, v23, 5, v21
  v_mul_u32_u24 v21, 2752, v21
  v_lshl_add_u32 v21, v22, 4, v21
  s_sub_u32 s44, s44, 1024
  v_add_u32 v4, s44, v21
  v_add_u32 v20, 128, v2
  v_mul_u32_u24 v21, 43691, v20
  v_lshrrev_b32 v21, 19, v21
  v_mul_u32_u24 v22, 12, v21
  v_sub_u32 v22, v20, v22
  v_lshrrev_b32 v23, 3, v21
  v_and_b32 v21, 7, v21
  v_lshl_add_u32 v21, v23, 5, v21
  v_mul_u32_u24 v21, 2752, v21
  v_lshl_add_u32 v21, v22, 4, v21
  s_sub_u32 s44, s44, 1024
  v_add_u32 v5, s44, v21
  s_mul_i32 s70, s36, 3072
  s_waitcnt lgkmcnt(0)
  s_mov_b32 s64, s8
  s_mov_b32 s65, s9
  s_mov_b32 s66, 0x200000
  s_mov_b32 s67, 0x20000
  s_cmp_lt_u32 s36, 2
  s_cselect_b32 s60, s24, s26
  s_cselect_b32 s61, s25, s27
  s_mov_b32 s62, 1409024
  s_mov_b32 s63, 0x20000
  s_mov_b32 s96, s34
  s_mov_b32 s97, s35
  s_mov_b32 s98, 10944512
  s_mov_b32 s99, 0x20000
  s_mov_b32 s56, s28
  s_mov_b32 s57, s29
  s_mov_b32 s58, 1409024
  s_mov_b32 s59, 0x20000
  s_cmp_ge_u32 s41, 15
  s_cbranch_scc1 G1SKIP_1
  s_and_b32 s3, s40, 7
  s_cmp_eq_u32 s3, 7
  s_cselect_b32 s3, 0, s3
  s_cselect_b32 s4, 1, 0
  s_lshl_b32 s3, s3, 7
  s_add_u32 s17, s3, 128
  s_add_u32 s18, s17, 128
  s_cmp_eq_u32 s18, 1024
  s_cselect_b32 s18, 128, s18
  s_add_u32 s19, s18, 128
  s_cmp_eq_u32 s19, 1024
  s_cselect_b32 s19, 128, s19
  s_cmp_eq_u32 s4, 1
  s_cselect_b32 s16, 128, 0
  s_cselect_b32 s17, 0, s17
  s_mul_i32 s68, s16, 1376
  s_add_u32 m0, s70, 0
  s_nop 0
  buffer_load_dwordx4 v3, s[60:63], s68 offen offset:0 lds
  buffer_load_dwordx4 v4, s[60:63], s68 offen offset:1024 lds
  buffer_load_dwordx4 v5, s[60:63], s68 offen offset:2048 lds
  buffer_load_dwordx4 v[192:195], v6, s[64:67], s16 offen offset:0
  buffer_load_dwordx4 v[196:199], v6, s[64:67], s16 offen offset:1024
  buffer_load_dwordx4 v[200:203], v6, s[64:67], s16 offen offset:2048
  buffer_load_dwordx4 v[204:207], v6, s[64:67], s16 offen offset:3072
  s_mov_b32 s10, 0x55555555
  s_mov_b32 s11, 0x55555555
  s_mov_b32 s12, 0x33333333
  s_mov_b32 s13, 0x33333333
  v_lshrrev_b32 v20, 5, v2
  v_bfe_u32 v21, v2, 2, 2
  v_lshl_add_u32 v20, v20, 3, v21
  v_mul_u32_u24 v20, 192, v20
  v_bfe_u32 v21, v2, 4, 1
  v_lshl_add_u32 v20, v21, 5, v20
  v_and_b32 v21, 3, v2
  v_lshl_add_u32 v8, v21, 3, v20
  v_add_u32 v7, 0x8000, v8
  v_lshlrev_b32 v9, 4, v2
  s_and_b32 s46, s37, 7
  s_lshl_b32 s46, s46, 2
  s_lshr_b32 s47, s37, 6
  s_add_u32 s46, s46, s47
  s_lshr_b32 s47, s37, 3
  s_and_b32 s47, s47, 7
  s_mul_i32 s14, s36, 360448
  s_lshl_b32 s69, s36, 12
  s_lshl_b32 s43, s40, 2
  s_add_u32 s43, s43, s36
  s_mul_i32 s44, s43, 88064
  s_lshl_b32 s45, s42, 6
  s_add_u32 s44, s44, s45
  s_add_u32 s48, s44, 5242880
  s_lshl_b32 s43, s43, 6
  s_lshl_b32 s44, s41, 2
  s_add_u32 s43, s43, s44
  s_add_u32 s49, s43, 8192
  s_lshr_b32 s43, s36, 1
  s_lshl_b32 s44, s46, 1
  s_add_u32 s45, s44, s43
  s_xor_b32 s43, s43, 1
  s_add_u32 s44, s44, s43
  s_mul_i32 s45, s45, 88064
  s_mul_i32 s44, s44, 88064
  s_mul_i32 s43, s36, 22528
  s_add_u32 s43, s43, 5242880
  s_add_u32 s52, s45, s43
  s_add_u32 s53, s44, s43
  s_lshl_b32 s43, s40, 7
  s_lshl_b32 s44, s36, 5
  s_add_u32 s43, s43, s44
  s_lshl_b32 s43, s43, 3
  s_add_u32 s44, s43, 65536
  s_lshl_b32 s45, s42, 4
  s_add_u32 s45, s45, 131072
  v_lshrrev_b32 v152, 3, v2
  v_lshlrev_b32 v152, 10, v152
  v_bfe_u32 v153, v2, 4, 1
  v_lshlrev_b32 v153, 2, v153
  v_and_b32 v154, 7, v2
  v_xor_b32 v153, v153, v154
  v_lshl_add_u32 v152, v153, 4, v152
  s_lshl_b32 s51, s47, 7
  v_add_u32 v152, s51, v152
  v_add_u32 v153, 7168, v152
  v_add_u32 v154, 14336, v152
  v_add_u32 v155, 21504, v152
  v_lshrrev_b32 v156, 5, v2
  v_bfe_u32 v157, v2, 2, 2
  v_lshl_add_u32 v156, v156, 2, v157
  v_lshlrev_b32 v156, 7, v156
  v_lshrrev_b32 v157, 1, v157
  v_lshl_add_u32 v156, v157, 6, v156
  v_bfe_u32 v157, v2, 4, 1
  v_lshl_add_u32 v156, v157, 5, v156
  v_and_b32 v157, 3, v2
  v_lshl_add_u32 v156, v157, 3, v156
  s_and_b32 s51, s36, 1
  s_lshl_b32 s51, s51, 6
  v_xor_b32 v156, s51, v156
  v_add_u32 v156, s69, v156
  v_xor_b32 v157, 64, v156
  v_add_u32 v158, 0x10000, v156
  s_add_u32 s20, s19, 128
  s_cmp_eq_u32 s20, 1024
  s_cselect_b32 s20, 128, s20
  s_add_u32 s21, s20, 128
  s_cmp_eq_u32 s21, 1024
  s_cselect_b32 s21, 128, s21
  s_add_u32 s22, s21, 128
  s_cmp_eq_u32 s22, 1024
  s_cselect_b32 s22, 128, s22
  s_add_u32 s23, s22, 128
  s_cmp_eq_u32 s23, 1024
  s_cselect_b32 s23, 128, s23
  s_cmp_eq_u32 s36, 3
  s_cselect_b32 s3, 0, s36
  s_lshl_b32 s3, s3, 11
  s_add_u32 s74, s3, 2048
  s_cmp_eq_u32 s74, 6144
  s_cselect_b32 s74, 0, s74
  s_add_u32 s75, s74, 2048
  s_cmp_eq_u32 s75, 6144
  s_cselect_b32 s75, 0, s75
  v_mov_b32 v20, v8
  s_lshr_b32 s4, s3, 5
  v_add_u32 v8, s4, v20
  s_lshr_b32 s4, s74, 5
  v_add_u32 v7, s4, v20
  s_lshr_b32 s4, s75, 5
  v_add_u32 v159, s4, v20
  s_lshr_b32 s43, s40, 3
  s_lshl_b32 s43, s43, 4
  s_add_u32 s43, s43, s41
  s_lshl_b32 s45, s43, 14
  s_add_u32 s45, s45, 131072
  s_lshl_b32 s4, s36, 12
  s_add_u32 s15, s45, s4
  s_and_b32 s4, s17, 0x300
  s_lshl_b32 s4, s4, 1
  s_add_u32 s15, s15, s4
  s_and_b32 s4, s17, 128
  s_lshr_b32 s4, s4, 4
  s_add_u32 s15, s15, s4
  v_and_b32 v20, 31, v2
  v_cmp_eq_u32 vcc, 0, v20
  v_cmp_eq_u32 s[4:5], 4, v20
  v_mov_b32 v21, 0x3f803f80
  v_cndmask_b32_e64 v12, 0, v21, vcc
  v_cndmask_b32_e64 v16, 0, v21, s[4:5]
  v_cndmask_b32_e64 v13, 0, v21, vcc
  v_cndmask_b32_e64 v17, 0, v21, s[4:5]
  v_cndmask_b32_e64 v14, 0, v21, vcc
  v_cndmask_b32_e64 v18, 0, v21, s[4:5]
  v_cndmask_b32_e64 v15, 0, v21, vcc
  v_cndmask_b32_e64 v19, 0, v21, s[4:5]
  s_add_u32 s68, s68, 44032
  s_add_u32 m0, s70, 12288
  s_nop 0
  buffer_load_dwordx4 v3, s[60:63], s68 offen offset:0 lds
  buffer_load_dwordx4 v4, s[60:63], s68 offen offset:1024 lds
  buffer_load_dwordx4 v5, s[60:63], s68 offen offset:2048 lds
  buffer_load_dwordx4 v[208:211], v6, s[64:67], s17 offen offset:0
  buffer_load_dwordx4 v[212:215], v6, s[64:67], s17 offen offset:1024
  buffer_load_dwordx4 v[216:219], v6, s[64:67], s17 offen offset:2048
  buffer_load_dwordx4 v[220:223], v6, s[64:67], s17 offen offset:3072
  s_mul_i32 s68, s17, 1376
  s_add_u32 m0, s70, 24576
  s_nop 0
  buffer_load_dwordx4 v3, s[60:63], s68 offen offset:0 lds
  buffer_load_dwordx4 v4, s[60:63], s68 offen offset:1024 lds
  buffer_load_dwordx4 v5, s[60:63], s68 offen offset:2048 lds
  s_waitcnt vmcnt(14)
  s_barrier
  ds_read_b64_tr_b16 v[120:121], v8 offset:0
  ds_read_b64_tr_b16 v[122:123], v8 offset:768
  ds_read_b64_tr_b16 v[124:125], v8 offset:6144
  ds_read_b64_tr_b16 v[126:127], v8 offset:6912
  ds_read_b64_tr_b16 v[128:129], v7 offset:0
  ds_read_b64_tr_b16 v[130:131], v7 offset:768
  ds_read_b64_tr_b16 v[132:133], v7 offset:6144
  ds_read_b64_tr_b16 v[134:135], v7 offset:6912
  ds_read_b64_tr_b16 v[136:137], v159 offset:0
  ds_read_b64_tr_b16 v[138:139], v159 offset:768
  ds_read_b64_tr_b16 v[140:141], v159 offset:6144
  ds_read_b64_tr_b16 v[142:143], v159 offset:6912
  ds_read_b64_tr_b16 v[144:145], v8 offset:3072
  ds_read_b64_tr_b16 v[146:147], v8 offset:3840
  ds_read_b64_tr_b16 v[148:149], v8 offset:9216
  ds_read_b64_tr_b16 v[150:151], v8 offset:9984
  s_waitcnt vmcnt(10)
  s_mov_b64 vcc, s[10:11]
  v_cndmask_b32_dpp v224, v196, v192, vcc quad_perm:[1,0,3,2] row_mask:0xf bank_mask:0xf
  v_cndmask_b32_dpp v226, v204, v200, vcc quad_perm:[1,0,3,2] row_mask:0xf bank_mask:0xf
  v_cndmask_b32_dpp v228, v197, v193, vcc quad_perm:[1,0,3,2] row_mask:0xf bank_mask:0xf
  v_cndmask_b32_dpp v230, v205, v201, vcc quad_perm:[1,0,3,2] row_mask:0xf bank_mask:0xf
  v_cndmask_b32_dpp v232, v198, v194, vcc quad_perm:[1,0,3,2] row_mask:0xf bank_mask:0xf
  v_cndmask_b32_dpp v234, v206, v202, vcc quad_perm:[1,0,3,2] row_mask:0xf bank_mask:0xf
  v_cndmask_b32_dpp v236, v199, v195, vcc quad_perm:[1,0,3,2] row_mask:0xf bank_mask:0xf
  v_cndmask_b32_dpp v238, v207, v203, vcc quad_perm:[1,0,3,2] row_mask:0xf bank_mask:0xf
  s_not_b64 vcc, vcc
  v_cndmask_b32_dpp v225, v192, v196, vcc quad_perm:[1,0,3,2] row_mask:0xf bank_mask:0xf
  v_cndmask_b32_dpp v227, v200, v204, vcc quad_perm:[1,0,3,2] row_mask:0xf bank_mask:0xf
  v_cndmask_b32_dpp v229, v193, v197, vcc quad_perm:[1,0,3,2] row_mask:0xf bank_mask:0xf
  v_cndmask_b32_dpp v231, v201, v205, vcc quad_perm:[1,0,3,2] row_mask:0xf bank_mask:0xf
  v_cndmask_b32_dpp v233, v194, v198, vcc quad_perm:[1,0,3,2] row_mask:0xf bank_mask:0xf
  v_cndmask_b32_dpp v235, v202, v206, vcc quad_perm:[1,0,3,2] row_mask:0xf bank_mask:0xf
  v_cndmask_b32_dpp v237, v195, v199, vcc quad_perm:[1,0,3,2] row_mask:0xf bank_mask:0xf
  v_cndmask_b32_dpp v239, v203, v207, vcc quad_perm:[1,0,3,2] row_mask:0xf bank_mask:0xf
  s_mov_b64 vcc, s[12:13]
  v_cndmask_b32_dpp v192, v226, v224, vcc quad_perm:[2,3,0,1] row_mask:0xf bank_mask:0xf
  v_cndmask_b32_dpp v193, v230, v228, vcc quad_perm:[2,3,0,1] row_mask:0xf bank_mask:0xf
  v_cndmask_b32_dpp v194, v234, v232, vcc quad_perm:[2,3,0,1] row_mask:0xf bank_mask:0xf
  v_cndmask_b32_dpp v195, v238, v236, vcc quad_perm:[2,3,0,1] row_mask:0xf bank_mask:0xf
  v_cndmask_b32_dpp v196, v227, v225, vcc quad_perm:[2,3,0,1] row_mask:0xf bank_mask:0xf
  v_cndmask_b32_dpp v197, v231, v229, vcc quad_perm:[2,3,0,1] row_mask:0xf bank_mask:0xf
  v_cndmask_b32_dpp v198, v235, v233, vcc quad_perm:[2,3,0,1] row_mask:0xf bank_mask:0xf
  v_cndmask_b32_dpp v199, v239, v237, vcc quad_perm:[2,3,0,1] row_mask:0xf bank_mask:0xf
  s_not_b64 vcc, vcc
  v_cndmask_b32_dpp v200, v224, v226, vcc quad_perm:[2,3,0,1] row_mask:0xf bank_mask:0xf
  v_cndmask_b32_dpp v201, v228, v230, vcc quad_perm:[2,3,0,1] row_mask:0xf bank_mask:0xf
  v_cndmask_b32_dpp v202, v232, v234, vcc quad_perm:[2,3,0,1] row_mask:0xf bank_mask:0xf
  v_cndmask_b32_dpp v203, v236, v238, vcc quad_perm:[2,3,0,1] row_mask:0xf bank_mask:0xf
  v_cndmask_b32_dpp v204, v225, v227, vcc quad_perm:[2,3,0,1] row_mask:0xf bank_mask:0xf
  v_cndmask_b32_dpp v205, v229, v231, vcc quad_perm:[2,3,0,1] row_mask:0xf bank_mask:0xf
  v_cndmask_b32_dpp v206, v233, v235, vcc quad_perm:[2,3,0,1] row_mask:0xf bank_mask:0xf
  v_cndmask_b32_dpp v207, v237, v239, vcc quad_perm:[2,3,0,1] row_mask:0xf bank_mask:0xf
  s_waitcnt vmcnt(3)
  s_mov_b64 vcc, s[10:11]
  v_cndmask_b32_dpp v224, v212, v208, vcc quad_perm:[1,0,3,2] row_mask:0xf bank_mask:0xf
  v_cndmask_b32_dpp v226, v220, v216, vcc quad_perm:[1,0,3,2] row_mask:0xf bank_mask:0xf
  s_waitcnt lgkmcnt(12)
  v_mfma_f32_32x32x16_bf16 v[24:39], v[120:123], v[192:195], 0
  ds_read_b64_tr_b16 v[120:121], v7 offset:3072
  ds_read_b64_tr_b16 v[122:123], v7 offset:3840
  buffer_load_dwordx4 v[160:163], v6, s[64:67], s18 offen offset:0
  s_waitcnt lgkmcnt(12)
  v_mfma_f32_32x32x16_bf16 v[40:55], v[124:127], v[192:195], 0
  ds_read_b64_tr_b16 v[124:125], v7 offset:9216
  ds_read_b64_tr_b16 v[126:127], v7 offset:9984
  buffer_load_dwordx4 v[164:167], v6, s[64:67], s18 offen offset:1024
  v_cndmask_b32_dpp v228, v213, v209, vcc quad_perm:[1,0,3,2] row_mask:0xf bank_mask:0xf
  v_cndmask_b32_dpp v230, v221, v217, vcc quad_perm:[1,0,3,2] row_mask:0xf bank_mask:0xf
  v_cndmask_b32_dpp v232, v214, v210, vcc quad_perm:[1,0,3,2] row_mask:0xf bank_mask:0xf
  v_mfma_f32_32x32x16_bf16 v[56:71], v[128:131], v[192:195], 0
  ds_read_b64_tr_b16 v[128:129], v159 offset:3072
  ds_read_b64_tr_b16 v[130:131], v159 offset:3840
  buffer_load_dwordx4 v[168:171], v6, s[64:67], s18 offen offset:2048
  s_waitcnt lgkmcnt(12)
  v_mfma_f32_32x32x16_bf16 v[72:87], v[132:135], v[192:195], 0
  ds_read_b64_tr_b16 v[132:133], v159 offset:9216
  ds_read_b64_tr_b16 v[134:135], v159 offset:9984
  s_add_u32 s68, s68, 44032
  s_add_u32 m0, s70, 36864
  buffer_load_dwordx4 v[172:175], v6, s[64:67], s18 offen offset:3072
  v_cndmask_b32_dpp v234, v222, v218, vcc quad_perm:[1,0,3,2] row_mask:0xf bank_mask:0xf
  v_cndmask_b32_dpp v236, v215, v211, vcc quad_perm:[1,0,3,2] row_mask:0xf bank_mask:0xf
  v_cndmask_b32_dpp v238, v223, v219, vcc quad_perm:[1,0,3,2] row_mask:0xf bank_mask:0xf
  v_mfma_f32_32x32x16_bf16 v[88:103], v[136:139], v[192:195], 0
  s_waitcnt lgkmcnt(10)
  s_barrier
  ds_read_b64_tr_b16 v[136:137], v8 offset:12288
  ds_read_b64_tr_b16 v[138:139], v8 offset:13056
  buffer_load_dwordx4 v3, s[60:63], s68 offen offset:0 lds
  v_mfma_f32_32x32x16_bf16 v[104:119], v[140:143], v[192:195], 0
  ds_read_b64_tr_b16 v[140:141], v8 offset:18432
  ds_read_b64_tr_b16 v[142:143], v8 offset:19200
  buffer_load_dwordx4 v4, s[60:63], s68 offen offset:1024 lds
  s_not_b64 vcc, vcc
  v_cndmask_b32_dpp v225, v208, v212, vcc quad_perm:[1,0,3,2] row_mask:0xf bank_mask:0xf
  v_cndmask_b32_dpp v227, v216, v220, vcc quad_perm:[1,0,3,2] row_mask:0xf bank_mask:0xf
  v_mfma_f32_32x32x16_bf16 v[24:39], v[144:147], v[196:199], v[24:39]
  ds_read_b64_tr_b16 v[144:145], v7 offset:12288
  ds_read_b64_tr_b16 v[146:147], v7 offset:13056
  buffer_load_dwordx4 v5, s[60:63], s68 offen offset:2048 lds
  s_waitcnt lgkmcnt(12)
  v_mfma_f32_32x32x16_bf16 v[40:55], v[148:151], v[196:199], v[40:55]
  ds_read_b64_tr_b16 v[148:149], v7 offset:18432
  ds_read_b64_tr_b16 v[150:151], v7 offset:19200
  s_mul_i32 s68, s18, 1376
  s_add_u32 m0, s70, 49152
  s_nop 0
  buffer_load_dwordx4 v3, s[60:63], s68 offen offset:0 lds
  v_cndmask_b32_dpp v229, v209, v213, vcc quad_perm:[1,0,3,2] row_mask:0xf bank_mask:0xf
  v_cndmask_b32_dpp v231, v217, v221, vcc quad_perm:[1,0,3,2] row_mask:0xf bank_mask:0xf
  v_cndmask_b32_dpp v233, v210, v214, vcc quad_perm:[1,0,3,2] row_mask:0xf bank_mask:0xf
  v_mfma_f32_32x32x16_bf16 v[56:71], v[120:123], v[196:199], v[56:71]
  ds_read_b64_tr_b16 v[120:121], v159 offset:12288
  ds_read_b64_tr_b16 v[122:123], v159 offset:13056
  buffer_load_dwordx4 v[176:179], v6, s[64:67], s19 offen offset:0
  s_waitcnt lgkmcnt(12)
  v_mfma_f32_32x32x16_bf16 v[72:87], v[124:127], v[196:199], v[72:87]
  ds_read_b64_tr_b16 v[124:125], v159 offset:18432
  ds_read_b64_tr_b16 v[126:127], v159 offset:19200
  buffer_load_dwordx4 v4, s[60:63], s68 offen offset:1024 lds
  v_cndmask_b32_dpp v235, v218, v222, vcc quad_perm:[1,0,3,2] row_mask:0xf bank_mask:0xf
  v_cndmask_b32_dpp v237, v211, v215, vcc quad_perm:[1,0,3,2] row_mask:0xf bank_mask:0xf
  v_cndmask_b32_dpp v239, v219, v223, vcc quad_perm:[1,0,3,2] row_mask:0xf bank_mask:0xf
  v_mfma_f32_32x32x16_bf16 v[88:103], v[128:131], v[196:199], v[88:103]
  ds_read_b64_tr_b16 v[128:129], v8 offset:15360
  ds_read_b64_tr_b16 v[130:131], v8 offset:16128
  s_waitcnt lgkmcnt(12)
  v_mfma_f32_32x32x16_bf16 v[104:119], v[132:135], v[196:199], v[104:119]
  ds_read_b64_tr_b16 v[132:133], v8 offset:21504
  ds_read_b64_tr_b16 v[134:135], v8 offset:22272
  buffer_load_dwordx4 v5, s[60:63], s68 offen offset:2048 lds
  s_mov_b64 vcc, s[12:13]
  v_cndmask_b32_dpp v208, v226, v224, vcc quad_perm:[2,3,0,1] row_mask:0xf bank_mask:0xf
  v_cndmask_b32_dpp v209, v230, v228, vcc quad_perm:[2,3,0,1] row_mask:0xf bank_mask:0xf
  v_mfma_f32_32x32x16_bf16 v[24:39], v[136:139], v[200:203], v[24:39]
  ds_read_b64_tr_b16 v[136:137], v7 offset:15360
  ds_read_b64_tr_b16 v[138:139], v7 offset:16128
  buffer_load_dwordx4 v[180:183], v6, s[64:67], s19 offen offset:1024
  v_mov_b32 v0, 0
  s_waitcnt lgkmcnt(12)
  v_mfma_f32_32x32x16_bf16 v[40:55], v[140:143], v[200:203], v[40:55]
  ds_read_b64_tr_b16 v[140:141], v7 offset:21504
  ds_read_b64_tr_b16 v[142:143], v7 offset:22272
  v_cndmask_b32_dpp v210, v234, v232, vcc quad_perm:[2,3,0,1] row_mask:0xf bank_mask:0xf
  v_cndmask_b32_dpp v211, v238, v236, vcc quad_perm:[2,3,0,1] row_mask:0xf bank_mask:0xf
  v_cndmask_b32_dpp v212, v227, v225, vcc quad_perm:[2,3,0,1] row_mask:0xf bank_mask:0xf
  global_load_dword v0, v0, s[34:35] sc1
  v_mfma_f32_32x32x16_bf16 v[56:71], v[144:147], v[200:203], v[56:71]
  ds_read_b64_tr_b16 v[144:145], v159 offset:15360
  ds_read_b64_tr_b16 v[146:147], v159 offset:16128
  s_waitcnt lgkmcnt(12)
  v_mfma_f32_32x32x16_bf16 v[72:87], v[148:151], v[200:203], v[72:87]
  ds_read_b64_tr_b16 v[148:149], v159 offset:21504
  ds_read_b64_tr_b16 v[150:151], v159 offset:22272
  v_cndmask_b32_dpp v213, v231, v229, vcc quad_perm:[2,3,0,1] row_mask:0xf bank_mask:0xf
  v_cndmask_b32_dpp v214, v235, v233, vcc quad_perm:[2,3,0,1] row_mask:0xf bank_mask:0xf
  v_cndmask_b32_dpp v215, v239, v237, vcc quad_perm:[2,3,0,1] row_mask:0xf bank_mask:0xf
  v_mfma_f32_32x32x16_bf16 v[88:103], v[120:123], v[200:203], v[88:103]
  s_waitcnt vmcnt(13) lgkmcnt(10)
  s_barrier
  ds_read_b64_tr_b16 v[120:121], v8 offset:24576
  ds_read_b64_tr_b16 v[122:123], v8 offset:25344
  s_add_u32 s68, s68, 44032
  s_add_u32 m0, s70, 0
  v_mfma_f32_32x32x16_bf16 v[104:119], v[124:127], v[200:203], v[104:119]
  ds_read_b64_tr_b16 v[124:125], v8 offset:30720
  ds_read_b64_tr_b16 v[126:127], v8 offset:31488
  s_not_b64 vcc, vcc
  v_cndmask_b32_dpp v216, v224, v226, vcc quad_perm:[2,3,0,1] row_mask:0xf bank_mask:0xf
  v_cndmask_b32_dpp v217, v228, v230, vcc quad_perm:[2,3,0,1] row_mask:0xf bank_mask:0xf
  v_mfma_f32_32x32x16_bf16 v[24:39], v[128:131], v[204:207], v[24:39]
  ds_read_b64_tr_b16 v[128:129], v7 offset:24576
  ds_read_b64_tr_b16 v[130:131], v7 offset:25344
  buffer_load_dwordx4 v3, s[60:63], s68 offen offset:0 lds
  s_waitcnt lgkmcnt(12)
  v_mfma_f32_32x32x16_bf16 v[40:55], v[132:135], v[204:207], v[40:55]
  ds_read_b64_tr_b16 v[132:133], v7 offset:30720
  ds_read_b64_tr_b16 v[134:135], v7 offset:31488
  v_cndmask_b32_dpp v218, v232, v234, vcc quad_perm:[2,3,0,1] row_mask:0xf bank_mask:0xf
  v_cndmask_b32_dpp v219, v236, v238, vcc quad_perm:[2,3,0,1] row_mask:0xf bank_mask:0xf
  v_cndmask_b32_dpp v220, v225, v227, vcc quad_perm:[2,3,0,1] row_mask:0xf bank_mask:0xf
  v_mfma_f32_32x32x16_bf16 v[56:71], v[136:139], v[204:207], v[56:71]
  ds_read_b64_tr_b16 v[136:137], v159 offset:24576
  ds_read_b64_tr_b16 v[138:139], v159 offset:25344
  buffer_load_dwordx4 v[184:187], v6, s[64:67], s19 offen offset:2048
  s_waitcnt lgkmcnt(12)
  v_mfma_f32_32x32x16_bf16 v[72:87], v[140:143], v[204:207], v[72:87]
  ds_read_b64_tr_b16 v[140:141], v159 offset:30720
  ds_read_b64_tr_b16 v[142:143], v159 offset:31488
  v_cndmask_b32_dpp v221, v229, v231, vcc quad_perm:[2,3,0,1] row_mask:0xf bank_mask:0xf
  v_cndmask_b32_dpp v222, v233, v235, vcc quad_perm:[2,3,0,1] row_mask:0xf bank_mask:0xf
  v_cndmask_b32_dpp v223, v237, v239, vcc quad_perm:[2,3,0,1] row_mask:0xf bank_mask:0xf
  v_mfma_f32_32x32x16_bf16 v[88:103], v[144:147], v[204:207], v[88:103]
  ds_read_b64_tr_b16 v[144:145], v8 offset:27648
  ds_read_b64_tr_b16 v[146:147], v8 offset:28416
  buffer_load_dwordx4 v4, s[60:63], s68 offen offset:1024 lds
  s_waitcnt vmcnt(12) lgkmcnt(12)
  v_mfma_f32_32x32x16_bf16 v[104:119], v[148:151], v[204:207], v[104:119]
  ds_read_b64_tr_b16 v[148:149], v8 offset:33792
  ds_read_b64_tr_b16 v[150:151], v8 offset:34560
  s_mov_b64 vcc, s[10:11]
  v_cndmask_b32_dpp v224, v164, v160, vcc quad_perm:[1,0,3,2] row_mask:0xf bank_mask:0xf
  v_cndmask_b32_dpp v226, v172, v168, vcc quad_perm:[1,0,3,2] row_mask:0xf bank_mask:0xf
  v_mfma_f32_32x32x16_bf16 v[24:39], v[120:123], v[208:211], v[24:39]
  v_mfma_f32_32x32x16_bf16 v[240:255], v[12:15], v[120:123], 0
  ds_read_b64_tr_b16 v[120:121], v7 offset:27648
  ds_read_b64_tr_b16 v[122:123], v7 offset:28416
  buffer_load_dwordx4 v[188:191], v6, s[64:67], s19 offen offset:3072
  s_waitcnt lgkmcnt(12)
  v_mfma_f32_32x32x16_bf16 v[40:55], v[124:127], v[208:211], v[40:55]
  v_mfma_f32_32x32x16_bf16 v[240:255], v[16:19], v[124:127], v[240:255]
  ds_read_b64_tr_b16 v[124:125], v7 offset:33792
  ds_read_b64_tr_b16 v[126:127], v7 offset:34560
  v_cndmask_b32_dpp v228, v165, v161, vcc quad_perm:[1,0,3,2] row_mask:0xf bank_mask:0xf
  v_cndmask_b32_dpp v230, v173, v169, vcc quad_perm:[1,0,3,2] row_mask:0xf bank_mask:0xf
  v_cndmask_b32_dpp v232, v166, v162, vcc quad_perm:[1,0,3,2] row_mask:0xf bank_mask:0xf
  v_mfma_f32_32x32x16_bf16 v[56:71], v[128:131], v[208:211], v[56:71]
  ds_read_b64_tr_b16 v[128:129], v159 offset:27648
  ds_read_b64_tr_b16 v[130:131], v159 offset:28416
  buffer_load_dwordx4 v5, s[60:63], s68 offen offset:2048 lds
  s_waitcnt lgkmcnt(12)
  v_mfma_f32_32x32x16_bf16 v[72:87], v[132:135], v[208:211], v[72:87]
  ds_read_b64_tr_b16 v[132:133], v159 offset:33792
  ds_read_b64_tr_b16 v[134:135], v159 offset:34560
  v_cndmask_b32_dpp v234, v174, v170, vcc quad_perm:[1,0,3,2] row_mask:0xf bank_mask:0xf
  v_cndmask_b32_dpp v236, v167, v163, vcc quad_perm:[1,0,3,2] row_mask:0xf bank_mask:0xf
  v_cndmask_b32_dpp v238, v175, v171, vcc quad_perm:[1,0,3,2] row_mask:0xf bank_mask:0xf
  v_mfma_f32_32x32x16_bf16 v[88:103], v[136:139], v[208:211], v[88:103]
  s_waitcnt vmcnt(11) lgkmcnt(10)
  s_barrier
  ds_read_b64_tr_b16 v[136:137], v8 offset:36864
  ds_read_b64_tr_b16 v[138:139], v8 offset:37632
  s_mul_i32 s68, s19, 1376
  s_add_u32 m0, s70, 12288
  v_mfma_f32_32x32x16_bf16 v[104:119], v[140:143], v[208:211], v[104:119]
  ds_read_b64_tr_b16 v[140:141], v8 offset:43008
  ds_read_b64_tr_b16 v[142:143], v8 offset:43776
  s_not_b64 vcc, vcc
  v_cndmask_b32_dpp v225, v160, v164, vcc quad_perm:[1,0,3,2] row_mask:0xf bank_mask:0xf
  v_cndmask_b32_dpp v227, v168, v172, vcc quad_perm:[1,0,3,2] row_mask:0xf bank_mask:0xf
  v_mfma_f32_32x32x16_bf16 v[24:39], v[144:147], v[212:215], v[24:39]
  v_mfma_f32_32x32x16_bf16 v[240:255], v[12:15], v[144:147], v[240:255]
  ds_read_b64_tr_b16 v[144:145], v7 offset:36864
  ds_read_b64_tr_b16 v[146:147], v7 offset:37632
  buffer_load_dwordx4 v3, s[60:63], s68 offen offset:0 lds
  s_waitcnt lgkmcnt(12)
  v_mfma_f32_32x32x16_bf16 v[40:55], v[148:151], v[212:215], v[40:55]
  v_mfma_f32_32x32x16_bf16 v[240:255], v[16:19], v[148:151], v[240:255]
  ds_read_b64_tr_b16 v[148:149], v7 offset:43008
  ds_read_b64_tr_b16 v[150:151], v7 offset:43776
  v_cndmask_b32_dpp v229, v161, v165, vcc quad_perm:[1,0,3,2] row_mask:0xf bank_mask:0xf
  v_cndmask_b32_dpp v231, v169, v173, vcc quad_perm:[1,0,3,2] row_mask:0xf bank_mask:0xf
  v_cndmask_b32_dpp v233, v162, v166, vcc quad_perm:[1,0,3,2] row_mask:0xf bank_mask:0xf
  v_mfma_f32_32x32x16_bf16 v[56:71], v[120:123], v[212:215], v[56:71]
  ds_read_b64_tr_b16 v[120:121], v159 offset:36864
  ds_read_b64_tr_b16 v[122:123], v159 offset:37632
  buffer_load_dwordx4 v[192:195], v6, s[64:67], s20 offen offset:0
  s_waitcnt lgkmcnt(12)
  v_mfma_f32_32x32x16_bf16 v[72:87], v[124:127], v[212:215], v[72:87]
  ds_read_b64_tr_b16 v[124:125], v159 offset:43008
  ds_read_b64_tr_b16 v[126:127], v159 offset:43776
  v_cndmask_b32_dpp v235, v170, v174, vcc quad_perm:[1,0,3,2] row_mask:0xf bank_mask:0xf
  v_cndmask_b32_dpp v237, v163, v167, vcc quad_perm:[1,0,3,2] row_mask:0xf bank_mask:0xf
  v_cndmask_b32_dpp v239, v171, v175, vcc quad_perm:[1,0,3,2] row_mask:0xf bank_mask:0xf
  v_mfma_f32_32x32x16_bf16 v[88:103], v[128:131], v[212:215], v[88:103]
  ds_read_b64_tr_b16 v[128:129], v8 offset:39936
  ds_read_b64_tr_b16 v[130:131], v8 offset:40704
  buffer_load_dwordx4 v4, s[60:63], s68 offen offset:1024 lds
  s_waitcnt lgkmcnt(12)
  v_mfma_f32_32x32x16_bf16 v[104:119], v[132:135], v[212:215], v[104:119]
  ds_read_b64_tr_b16 v[132:133], v8 offset:46080
  ds_read_b64_tr_b16 v[134:135], v8 offset:46848
  s_mov_b64 vcc, s[12:13]
  v_cndmask_b32_dpp v160, v226, v224, vcc quad_perm:[2,3,0,1] row_mask:0xf bank_mask:0xf
  v_cndmask_b32_dpp v161, v230, v228, vcc quad_perm:[2,3,0,1] row_mask:0xf bank_mask:0xf
  v_mfma_f32_32x32x16_bf16 v[24:39], v[136:139], v[216:219], v[24:39]
  v_mfma_f32_32x32x16_bf16 v[240:255], v[12:15], v[136:139], v[240:255]
  ds_read_b64_tr_b16 v[136:137], v7 offset:39936
  ds_read_b64_tr_b16 v[138:139], v7 offset:40704
  buffer_load_dwordx4 v[196:199], v6, s[64:67], s20 offen offset:1024
  s_waitcnt lgkmcnt(12)
  v_mfma_f32_32x32x16_bf16 v[40:55], v[140:143], v[216:219], v[40:55]
  v_mfma_f32_32x32x16_bf16 v[240:255], v[16:19], v[140:143], v[240:255]
  ds_read_b64_tr_b16 v[140:141], v7 offset:46080
  ds_read_b64_tr_b16 v[142:143], v7 offset:46848
  v_cndmask_b32_dpp v162, v234, v232, vcc quad_perm:[2,3,0,1] row_mask:0xf bank_mask:0xf
  v_cndmask_b32_dpp v163, v238, v236, vcc quad_perm:[2,3,0,1] row_mask:0xf bank_mask:0xf
  v_cndmask_b32_dpp v164, v227, v225, vcc quad_perm:[2,3,0,1] row_mask:0xf bank_mask:0xf
  v_mfma_f32_32x32x16_bf16 v[56:71], v[144:147], v[216:219], v[56:71]
  ds_read_b64_tr_b16 v[144:145], v159 offset:39936
  ds_read_b64_tr_b16 v[146:147], v159 offset:40704
  buffer_load_dwordx4 v5, s[60:63], s68 offen offset:2048 lds
  s_waitcnt lgkmcnt(12)
  v_mfma_f32_32x32x16_bf16 v[72:87], v[148:151], v[216:219], v[72:87]
  ds_read_b64_tr_b16 v[148:149], v159 offset:46080
  ds_read_b64_tr_b16 v[150:151], v159 offset:46848
  v_cndmask_b32_dpp v165, v231, v229, vcc quad_perm:[2,3,0,1] row_mask:0xf bank_mask:0xf
  v_cndmask_b32_dpp v166, v235, v233, vcc quad_perm:[2,3,0,1] row_mask:0xf bank_mask:0xf
  v_cndmask_b32_dpp v167, v239, v237, vcc quad_perm:[2,3,0,1] row_mask:0xf bank_mask:0xf
  v_mfma_f32_32x32x16_bf16 v[88:103], v[120:123], v[216:219], v[88:103]
  s_waitcnt vmcnt(12) lgkmcnt(10)
  s_barrier
  ds_read_b64_tr_b16 v[120:121], v8 offset:49152
  ds_read_b64_tr_b16 v[122:123], v8 offset:49920
  s_add_u32 s68, s68, 44032
  s_add_u32 m0, s70, 24576
  v_mfma_f32_32x32x16_bf16 v[104:119], v[124:127], v[216:219], v[104:119]
  ds_read_b64_tr_b16 v[124:125], v8 offset:55296
  ds_read_b64_tr_b16 v[126:127], v8 offset:56064
  s_not_b64 vcc, vcc
  v_cndmask_b32_dpp v168, v224, v226, vcc quad_perm:[2,3,0,1] row_mask:0xf bank_mask:0xf
  v_cndmask_b32_dpp v169, v228, v230, vcc quad_perm:[2,3,0,1] row_mask:0xf bank_mask:0xf
  v_mfma_f32_32x32x16_bf16 v[24:39], v[128:131], v[220:223], v[24:39]
  v_mfma_f32_32x32x16_bf16 v[240:255], v[12:15], v[128:131], v[240:255]
  ds_read_b64_tr_b16 v[128:129], v7 offset:49152
  ds_read_b64_tr_b16 v[130:131], v7 offset:49920
  buffer_load_dwordx4 v3, s[60:63], s68 offen offset:0 lds
  s_waitcnt lgkmcnt(12)
  v_mfma_f32_32x32x16_bf16 v[40:55], v[132:135], v[220:223], v[40:55]
  v_mfma_f32_32x32x16_bf16 v[240:255], v[16:19], v[132:135], v[240:255]
  ds_read_b64_tr_b16 v[132:133], v7 offset:55296
  ds_read_b64_tr_b16 v[134:135], v7 offset:56064
  v_cndmask_b32_dpp v170, v232, v234, vcc quad_perm:[2,3,0,1] row_mask:0xf bank_mask:0xf
  v_cndmask_b32_dpp v171, v236, v238, vcc quad_perm:[2,3,0,1] row_mask:0xf bank_mask:0xf
  v_cndmask_b32_dpp v172, v225, v227, vcc quad_perm:[2,3,0,1] row_mask:0xf bank_mask:0xf
  v_mfma_f32_32x32x16_bf16 v[56:71], v[136:139], v[220:223], v[56:71]
  ds_read_b64_tr_b16 v[136:137], v159 offset:49152
  ds_read_b64_tr_b16 v[138:139], v159 offset:49920
  buffer_load_dwordx4 v[200:203], v6, s[64:67], s20 offen offset:2048
  s_waitcnt lgkmcnt(12)
  v_mfma_f32_32x32x16_bf16 v[72:87], v[140:143], v[220:223], v[72:87]
  ds_read_b64_tr_b16 v[140:141], v159 offset:55296
  ds_read_b64_tr_b16 v[142:143], v159 offset:56064
  v_cndmask_b32_dpp v173, v229, v231, vcc quad_perm:[2,3,0,1] row_mask:0xf bank_mask:0xf
  v_cndmask_b32_dpp v174, v233, v235, vcc quad_perm:[2,3,0,1] row_mask:0xf bank_mask:0xf
  v_cndmask_b32_dpp v175, v237, v239, vcc quad_perm:[2,3,0,1] row_mask:0xf bank_mask:0xf
  v_mfma_f32_32x32x16_bf16 v[88:103], v[144:147], v[220:223], v[88:103]
  ds_read_b64_tr_b16 v[144:145], v8 offset:52224
  ds_read_b64_tr_b16 v[146:147], v8 offset:52992
  buffer_load_dwordx4 v4, s[60:63], s68 offen offset:1024 lds
  s_waitcnt vmcnt(9) lgkmcnt(12)
  v_mfma_f32_32x32x16_bf16 v[104:119], v[148:151], v[220:223], v[104:119]
  ds_read_b64_tr_b16 v[148:149], v8 offset:58368
  ds_read_b64_tr_b16 v[150:151], v8 offset:59136
  s_mov_b64 vcc, s[10:11]
  v_cndmask_b32_dpp v224, v180, v176, vcc quad_perm:[1,0,3,2] row_mask:0xf bank_mask:0xf
  v_cndmask_b32_dpp v226, v188, v184, vcc quad_perm:[1,0,3,2] row_mask:0xf bank_mask:0xf
  v_mfma_f32_32x32x16_bf16 v[24:39], v[120:123], v[160:163], v[24:39]
  ds_read_b64_tr_b16 v[120:121], v7 offset:52224
  ds_read_b64_tr_b16 v[122:123], v7 offset:52992
  buffer_load_dwordx4 v[204:207], v6, s[64:67], s20 offen offset:3072
  s_waitcnt lgkmcnt(12)
  v_mfma_f32_32x32x16_bf16 v[40:55], v[124:127], v[160:163], v[40:55]
  ds_read_b64_tr_b16 v[124:125], v7 offset:58368
  ds_read_b64_tr_b16 v[126:127], v7 offset:59136
  v_cndmask_b32_dpp v228, v181, v177, vcc quad_perm:[1,0,3,2] row_mask:0xf bank_mask:0xf
  v_cndmask_b32_dpp v230, v189, v185, vcc quad_perm:[1,0,3,2] row_mask:0xf bank_mask:0xf
  v_cndmask_b32_dpp v232, v182, v178, vcc quad_perm:[1,0,3,2] row_mask:0xf bank_mask:0xf
  v_mfma_f32_32x32x16_bf16 v[56:71], v[128:131], v[160:163], v[56:71]
  ds_read_b64_tr_b16 v[128:129], v159 offset:52224
  ds_read_b64_tr_b16 v[130:131], v159 offset:52992
  buffer_load_dwordx4 v5, s[60:63], s68 offen offset:2048 lds
  s_waitcnt lgkmcnt(12)
  v_mfma_f32_32x32x16_bf16 v[72:87], v[132:135], v[160:163], v[72:87]
  ds_read_b64_tr_b16 v[132:133], v159 offset:58368
  ds_read_b64_tr_b16 v[134:135], v159 offset:59136
  v_cndmask_b32_dpp v234, v190, v186, vcc quad_perm:[1,0,3,2] row_mask:0xf bank_mask:0xf
  v_cndmask_b32_dpp v236, v183, v179, vcc quad_perm:[1,0,3,2] row_mask:0xf bank_mask:0xf
  v_cndmask_b32_dpp v238, v191, v187, vcc quad_perm:[1,0,3,2] row_mask:0xf bank_mask:0xf
  v_cvt_pk_bf16_f32 v23, v240, v240
  v_mfma_f32_32x32x16_bf16 v[88:103], v[136:139], v[160:163], v[88:103]
  s_waitcnt vmcnt(10) lgkmcnt(10)
  s_barrier
  ds_read_b64_tr_b16 v[136:137], v8 offset:0
  ds_read_b64_tr_b16 v[138:139], v8 offset:768
  s_mul_i32 s68, s20, 1376
  s_add_u32 m0, s70, 36864
  v_lshrrev_b32 v20, 5, v2
  v_mfma_f32_32x32x16_bf16 v[104:119], v[140:143], v[160:163], v[104:119]
  ds_read_b64_tr_b16 v[140:141], v8 offset:6144
  ds_read_b64_tr_b16 v[142:143], v8 offset:6912
  s_not_b64 vcc, vcc
  v_cndmask_b32_dpp v225, v176, v180, vcc quad_perm:[1,0,3,2] row_mask:0xf bank_mask:0xf
  v_cndmask_b32_dpp v227, v184, v188, vcc quad_perm:[1,0,3,2] row_mask:0xf bank_mask:0xf
  v_lshlrev_b32 v23, 16, v23
  v_mfma_f32_32x32x16_bf16 v[24:39], v[144:147], v[164:167], v[24:39]
  ds_read_b64_tr_b16 v[144:145], v7 offset:0
  ds_read_b64_tr_b16 v[146:147], v7 offset:768
  buffer_load_dwordx4 v3, s[60:63], s68 offen offset:0 lds
  v_readfirstlane_b32 s38, v0
  v_mul_u32_u24 v20, 1536, v20
  s_waitcnt lgkmcnt(12)
  v_mfma_f32_32x32x16_bf16 v[40:55], v[148:151], v[164:167], v[40:55]
  ds_read_b64_tr_b16 v[148:149], v7 offset:6144
  ds_read_b64_tr_b16 v[150:151], v7 offset:6912
  v_cndmask_b32_dpp v229, v177, v181, vcc quad_perm:[1,0,3,2] row_mask:0xf bank_mask:0xf
  v_cndmask_b32_dpp v231, v185, v189, vcc quad_perm:[1,0,3,2] row_mask:0xf bank_mask:0xf
  v_cndmask_b32_dpp v233, v178, v182, vcc quad_perm:[1,0,3,2] row_mask:0xf bank_mask:0xf
  s_mul_i32 s38, s38, 0x9E3779B1
  v_sub_f32 v22, v240, v23
  v_mfma_f32_32x32x16_bf16 v[56:71], v[120:123], v[164:167], v[56:71]
  ds_read_b64_tr_b16 v[120:121], v159 offset:0
  ds_read_b64_tr_b16 v[122:123], v159 offset:768
  buffer_load_dwordx4 v[208:211], v6, s[64:67], s21 offen offset:0
  s_add_u32 s38, s38, 0x7F4A7C15
  v_add_u32 v20, v20, v9
  s_waitcnt lgkmcnt(12)
  v_mfma_f32_32x32x16_bf16 v[72:87], v[124:127], v[164:167], v[72:87]
  ds_read_b64_tr_b16 v[124:125], v159 offset:6144
  ds_read_b64_tr_b16 v[126:127], v159 offset:6912
  v_cndmask_b32_dpp v235, v186, v190, vcc quad_perm:[1,0,3,2] row_mask:0xf bank_mask:0xf
  v_cndmask_b32_dpp v237, v179, v183, vcc quad_perm:[1,0,3,2] row_mask:0xf bank_mask:0xf
  v_cndmask_b32_dpp v239, v187, v191, vcc quad_perm:[1,0,3,2] row_mask:0xf bank_mask:0xf
  s_and_b32 s38, s38, 0xBFFFBFFF
  v_cvt_pk_bf16_f32 v22, v23, v22
  v_mfma_f32_32x32x16_bf16 v[88:103], v[128:131], v[164:167], v[88:103]
  ds_read_b64_tr_b16 v[128:129], v8 offset:3072
  ds_read_b64_tr_b16 v[130:131], v8 offset:3840
  buffer_load_dwordx4 v4, s[60:63], s68 offen offset:1024 lds
  s_waitcnt lgkmcnt(12)
  v_mfma_f32_32x32x16_bf16 v[104:119], v[132:135], v[164:167], v[104:119]
  ds_read_b64_tr_b16 v[132:133], v8 offset:9216
  ds_read_b64_tr_b16 v[134:135], v8 offset:9984
  s_mov_b64 vcc, s[12:13]
  v_cndmask_b32_dpp v176, v226, v224, vcc quad_perm:[2,3,0,1] row_mask:0xf bank_mask:0xf
  v_cndmask_b32_dpp v177, v230, v228, vcc quad_perm:[2,3,0,1] row_mask:0xf bank_mask:0xf
  v_mfma_f32_32x32x16_bf16 v[24:39], v[136:139], v[168:171], v[24:39]
  ds_read_b64_tr_b16 v[136:137], v7 offset:3072
  ds_read_b64_tr_b16 v[138:139], v7 offset:3840
  buffer_load_dwordx4 v[212:215], v6, s[64:67], s21 offen offset:1024
  s_waitcnt lgkmcnt(12)
  v_mfma_f32_32x32x16_bf16 v[40:55], v[140:143], v[168:171], v[40:55]
  ds_read_b64_tr_b16 v[140:141], v7 offset:9216
  ds_read_b64_tr_b16 v[142:143], v7 offset:9984
  v_cndmask_b32_dpp v178, v234, v232, vcc quad_perm:[2,3,0,1] row_mask:0xf bank_mask:0xf
  v_cndmask_b32_dpp v179, v238, v236, vcc quad_perm:[2,3,0,1] row_mask:0xf bank_mask:0xf
  v_cndmask_b32_dpp v180, v227, v225, vcc quad_perm:[2,3,0,1] row_mask:0xf bank_mask:0xf
  v_mfma_f32_32x32x16_bf16 v[56:71], v[144:147], v[168:171], v[56:71]
  ds_read_b64_tr_b16 v[144:145], v159 offset:3072
  ds_read_b64_tr_b16 v[146:147], v159 offset:3840
  buffer_load_dwordx4 v5, s[60:63], s68 offen offset:2048 lds
  v_mov_b32 v23, s38
  s_waitcnt lgkmcnt(12)
  v_mfma_f32_32x32x16_bf16 v[72:87], v[148:151], v[168:171], v[72:87]
  ds_read_b64_tr_b16 v[148:149], v159 offset:9216
  ds_read_b64_tr_b16 v[150:151], v159 offset:9984
  v_cndmask_b32_dpp v181, v231, v229, vcc quad_perm:[2,3,0,1] row_mask:0xf bank_mask:0xf
  v_cndmask_b32_dpp v182, v235, v233, vcc quad_perm:[2,3,0,1] row_mask:0xf bank_mask:0xf
  v_cndmask_b32_dpp v183, v239, v237, vcc quad_perm:[2,3,0,1] row_mask:0xf bank_mask:0xf
  buffer_store_dwordx2 v[22:23], v20, s[96:99], s15 offen sc1
  v_mfma_f32_32x32x16_bf16 v[88:103], v[120:123], v[168:171], v[88:103]
  s_waitcnt vmcnt(11) lgkmcnt(10)
  s_barrier
  ds_read_b64_tr_b16 v[120:121], v8 offset:12288
  ds_read_b64_tr_b16 v[122:123], v8 offset:13056
  s_add_u32 s68, s68, 44032
  s_add_u32 m0, s70, 49152
  v_mfma_f32_32x32x16_bf16 v[104:119], v[124:127], v[168:171], v[104:119]
  ds_read_b64_tr_b16 v[124:125], v8 offset:18432
  ds_read_b64_tr_b16 v[126:127], v8 offset:19200
  s_not_b64 vcc, vcc
  v_cndmask_b32_dpp v184, v224, v226, vcc quad_perm:[2,3,0,1] row_mask:0xf bank_mask:0xf
  v_cndmask_b32_dpp v185, v228, v230, vcc quad_perm:[2,3,0,1] row_mask:0xf bank_mask:0xf
  v_mfma_f32_32x32x16_bf16 v[24:39], v[128:131], v[172:175], v[24:39]
  ds_read_b64_tr_b16 v[128:129], v7 offset:12288
  ds_read_b64_tr_b16 v[130:131], v7 offset:13056
  buffer_load_dwordx4 v3, s[60:63], s68 offen offset:0 lds
  s_waitcnt lgkmcnt(12)
  v_mfma_f32_32x32x16_bf16 v[40:55], v[132:135], v[172:175], v[40:55]
  ds_read_b64_tr_b16 v[132:133], v7 offset:18432
  ds_read_b64_tr_b16 v[134:135], v7 offset:19200
  v_cndmask_b32_dpp v186, v232, v234, vcc quad_perm:[2,3,0,1] row_mask:0xf bank_mask:0xf
  v_cndmask_b32_dpp v187, v236, v238, vcc quad_perm:[2,3,0,1] row_mask:0xf bank_mask:0xf
  v_cndmask_b32_dpp v188, v225, v227, vcc quad_perm:[2,3,0,1] row_mask:0xf bank_mask:0xf
  v_mfma_f32_32x32x16_bf16 v[56:71], v[136:139], v[172:175], v[56:71]
  ds_read_b64_tr_b16 v[136:137], v159 offset:12288
  ds_read_b64_tr_b16 v[138:139], v159 offset:13056
  buffer_load_dwordx4 v[216:219], v6, s[64:67], s21 offen offset:2048
  s_waitcnt lgkmcnt(12)
  v_mfma_f32_32x32x16_bf16 v[72:87], v[140:143], v[172:175], v[72:87]
  ds_read_b64_tr_b16 v[140:141], v159 offset:18432
  ds_read_b64_tr_b16 v[142:143], v159 offset:19200
  v_cndmask_b32_dpp v189, v229, v231, vcc quad_perm:[2,3,0,1] row_mask:0xf bank_mask:0xf
  v_cndmask_b32_dpp v190, v233, v235, vcc quad_perm:[2,3,0,1] row_mask:0xf bank_mask:0xf
  v_cndmask_b32_dpp v191, v237, v239, vcc quad_perm:[2,3,0,1] row_mask:0xf bank_mask:0xf
  v_mfma_f32_32x32x16_bf16 v[88:103], v[144:147], v[172:175], v[88:103]
  ds_read_b64_tr_b16 v[144:145], v8 offset:15360
  ds_read_b64_tr_b16 v[146:147], v8 offset:16128
  buffer_load_dwordx4 v4, s[60:63], s68 offen offset:1024 lds
  s_waitcnt vmcnt(10) lgkmcnt(12)
  v_mfma_f32_32x32x16_bf16 v[104:119], v[148:151], v[172:175], v[104:119]
  ds_read_b64_tr_b16 v[148:149], v8 offset:21504
  ds_read_b64_tr_b16 v[150:151], v8 offset:22272
  s_mov_b64 vcc, s[10:11]
  v_cndmask_b32_dpp v224, v196, v192, vcc quad_perm:[1,0,3,2] row_mask:0xf bank_mask:0xf
  v_cndmask_b32_dpp v226, v204, v200, vcc quad_perm:[1,0,3,2] row_mask:0xf bank_mask:0xf
  v_mfma_f32_32x32x16_bf16 v[24:39], v[120:123], v[176:179], v[24:39]
  ds_read_b64_tr_b16 v[120:121], v7 offset:15360
  ds_read_b64_tr_b16 v[122:123], v7 offset:16128
  buffer_load_dwordx4 v[220:223], v6, s[64:67], s21 offen offset:3072
  s_waitcnt lgkmcnt(12)
  v_mfma_f32_32x32x16_bf16 v[40:55], v[124:127], v[176:179], v[40:55]
  ds_read_b64_tr_b16 v[124:125], v7 offset:21504
  ds_read_b64_tr_b16 v[126:127], v7 offset:22272
  v_cndmask_b32_dpp v228, v197, v193, vcc quad_perm:[1,0,3,2] row_mask:0xf bank_mask:0xf
  v_cndmask_b32_dpp v230, v205, v201, vcc quad_perm:[1,0,3,2] row_mask:0xf bank_mask:0xf
  v_cndmask_b32_dpp v232, v198, v194, vcc quad_perm:[1,0,3,2] row_mask:0xf bank_mask:0xf
  v_mfma_f32_32x32x16_bf16 v[56:71], v[128:131], v[176:179], v[56:71]
  ds_read_b64_tr_b16 v[128:129], v159 offset:15360
  ds_read_b64_tr_b16 v[130:131], v159 offset:16128
  buffer_load_dwordx4 v5, s[60:63], s68 offen offset:2048 lds
  s_waitcnt lgkmcnt(12)
  v_mfma_f32_32x32x16_bf16 v[72:87], v[132:135], v[176:179], v[72:87]
  ds_read_b64_tr_b16 v[132:133], v159 offset:21504
  ds_read_b64_tr_b16 v[134:135], v159 offset:22272
  v_cndmask_b32_dpp v234, v206, v202, vcc quad_perm:[1,0,3,2] row_mask:0xf bank_mask:0xf
  v_cndmask_b32_dpp v236, v199, v195, vcc quad_perm:[1,0,3,2] row_mask:0xf bank_mask:0xf
  v_cndmask_b32_dpp v238, v207, v203, vcc quad_perm:[1,0,3,2] row_mask:0xf bank_mask:0xf
  v_mfma_f32_32x32x16_bf16 v[88:103], v[136:139], v[176:179], v[88:103]
  s_waitcnt vmcnt(11) lgkmcnt(10)
  s_barrier
  ds_read_b64_tr_b16 v[136:137], v8 offset:24576
  ds_read_b64_tr_b16 v[138:139], v8 offset:25344
  s_mul_i32 s68, s21, 1376
  s_add_u32 m0, s70, 0
  v_mfma_f32_32x32x16_bf16 v[104:119], v[140:143], v[176:179], v[104:119]
  ds_read_b64_tr_b16 v[140:141], v8 offset:30720
  ds_read_b64_tr_b16 v[142:143], v8 offset:31488
  s_not_b64 vcc, vcc
  v_cndmask_b32_dpp v225, v192, v196, vcc quad_perm:[1,0,3,2] row_mask:0xf bank_mask:0xf
  v_cndmask_b32_dpp v227, v200, v204, vcc quad_perm:[1,0,3,2] row_mask:0xf bank_mask:0xf
  v_mfma_f32_32x32x16_bf16 v[24:39], v[144:147], v[180:183], v[24:39]
  ds_read_b64_tr_b16 v[144:145], v7 offset:24576
  ds_read_b64_tr_b16 v[146:147], v7 offset:25344
  buffer_load_dwordx4 v3, s[60:63], s68 offen offset:0 lds
  s_waitcnt lgkmcnt(12)
  v_mfma_f32_32x32x16_bf16 v[40:55], v[148:151], v[180:183], v[40:55]
  ds_read_b64_tr_b16 v[148:149], v7 offset:30720
  ds_read_b64_tr_b16 v[150:151], v7 offset:31488
  v_cndmask_b32_dpp v229, v193, v197, vcc quad_perm:[1,0,3,2] row_mask:0xf bank_mask:0xf
  v_cndmask_b32_dpp v231, v201, v205, vcc quad_perm:[1,0,3,2] row_mask:0xf bank_mask:0xf
  v_cndmask_b32_dpp v233, v194, v198, vcc quad_perm:[1,0,3,2] row_mask:0xf bank_mask:0xf
  v_mfma_f32_32x32x16_bf16 v[56:71], v[120:123], v[180:183], v[56:71]
  ds_read_b64_tr_b16 v[120:121], v159 offset:24576
  ds_read_b64_tr_b16 v[122:123], v159 offset:25344
  buffer_load_dwordx4 v[160:163], v6, s[64:67], s22 offen offset:0
  s_waitcnt lgkmcnt(12)
  v_mfma_f32_32x32x16_bf16 v[72:87], v[124:127], v[180:183], v[72:87]
  ds_read_b64_tr_b16 v[124:125], v159 offset:30720
  ds_read_b64_tr_b16 v[126:127], v159 offset:31488
  v_cndmask_b32_dpp v235, v202, v206, vcc quad_perm:[1,0,3,2] row_mask:0xf bank_mask:0xf
  v_cndmask_b32_dpp v237, v195, v199, vcc quad_perm:[1,0,3,2] row_mask:0xf bank_mask:0xf
  v_cndmask_b32_dpp v239, v203, v207, vcc quad_perm:[1,0,3,2] row_mask:0xf bank_mask:0xf
  v_mfma_f32_32x32x16_bf16 v[88:103], v[128:131], v[180:183], v[88:103]
  ds_read_b64_tr_b16 v[128:129], v8 offset:27648
  ds_read_b64_tr_b16 v[130:131], v8 offset:28416
  buffer_load_dwordx4 v4, s[60:63], s68 offen offset:1024 lds
  s_waitcnt lgkmcnt(12)
  v_mfma_f32_32x32x16_bf16 v[104:119], v[132:135], v[180:183], v[104:119]
  ds_read_b64_tr_b16 v[132:133], v8 offset:33792
  ds_read_b64_tr_b16 v[134:135], v8 offset:34560
  s_mov_b64 vcc, s[12:13]
  v_cndmask_b32_dpp v192, v226, v224, vcc quad_perm:[2,3,0,1] row_mask:0xf bank_mask:0xf
  v_cndmask_b32_dpp v193, v230, v228, vcc quad_perm:[2,3,0,1] row_mask:0xf bank_mask:0xf
  v_mfma_f32_32x32x16_bf16 v[24:39], v[136:139], v[184:187], v[24:39]
  ds_read_b64_tr_b16 v[136:137], v7 offset:27648
  ds_read_b64_tr_b16 v[138:139], v7 offset:28416
  buffer_load_dwordx4 v[164:167], v6, s[64:67], s22 offen offset:1024
  s_waitcnt lgkmcnt(12)
  v_mfma_f32_32x32x16_bf16 v[40:55], v[140:143], v[184:187], v[40:55]
  ds_read_b64_tr_b16 v[140:141], v7 offset:33792
  ds_read_b64_tr_b16 v[142:143], v7 offset:34560
  v_cndmask_b32_dpp v194, v234, v232, vcc quad_perm:[2,3,0,1] row_mask:0xf bank_mask:0xf
  v_cndmask_b32_dpp v195, v238, v236, vcc quad_perm:[2,3,0,1] row_mask:0xf bank_mask:0xf
  v_cndmask_b32_dpp v196, v227, v225, vcc quad_perm:[2,3,0,1] row_mask:0xf bank_mask:0xf
  v_mfma_f32_32x32x16_bf16 v[56:71], v[144:147], v[184:187], v[56:71]
  ds_read_b64_tr_b16 v[144:145], v159 offset:27648
  ds_read_b64_tr_b16 v[146:147], v159 offset:28416
  buffer_load_dwordx4 v5, s[60:63], s68 offen offset:2048 lds
  s_waitcnt lgkmcnt(12)
  v_mfma_f32_32x32x16_bf16 v[72:87], v[148:151], v[184:187], v[72:87]
  ds_read_b64_tr_b16 v[148:149], v159 offset:33792
  ds_read_b64_tr_b16 v[150:151], v159 offset:34560
  v_cndmask_b32_dpp v197, v231, v229, vcc quad_perm:[2,3,0,1] row_mask:0xf bank_mask:0xf
  v_cndmask_b32_dpp v198, v235, v233, vcc quad_perm:[2,3,0,1] row_mask:0xf bank_mask:0xf
  v_cndmask_b32_dpp v199, v239, v237, vcc quad_perm:[2,3,0,1] row_mask:0xf bank_mask:0xf
  v_mfma_f32_32x32x16_bf16 v[88:103], v[120:123], v[184:187], v[88:103]
  s_waitcnt vmcnt(11) lgkmcnt(10)
  s_barrier
  ds_read_b64_tr_b16 v[120:121], v8 offset:36864
  ds_read_b64_tr_b16 v[122:123], v8 offset:37632
  s_add_u32 s68, s68, 44032
  s_add_u32 m0, s70, 12288
  v_mfma_f32_32x32x16_bf16 v[104:119], v[124:127], v[184:187], v[104:119]
  ds_read_b64_tr_b16 v[124:125], v8 offset:43008
  ds_read_b64_tr_b16 v[126:127], v8 offset:43776
  s_not_b64 vcc, vcc
  v_cndmask_b32_dpp v200, v224, v226, vcc quad_perm:[2,3,0,1] row_mask:0xf bank_mask:0xf
  v_cndmask_b32_dpp v201, v228, v230, vcc quad_perm:[2,3,0,1] row_mask:0xf bank_mask:0xf
  v_mfma_f32_32x32x16_bf16 v[24:39], v[128:131], v[188:191], v[24:39]
  ds_read_b64_tr_b16 v[128:129], v7 offset:36864
  ds_read_b64_tr_b16 v[130:131], v7 offset:37632
  buffer_load_dwordx4 v3, s[60:63], s68 offen offset:0 lds
  s_waitcnt lgkmcnt(12)
  v_mfma_f32_32x32x16_bf16 v[40:55], v[132:135], v[188:191], v[40:55]
  ds_read_b64_tr_b16 v[132:133], v7 offset:43008
  ds_read_b64_tr_b16 v[134:135], v7 offset:43776
  v_cndmask_b32_dpp v202, v232, v234, vcc quad_perm:[2,3,0,1] row_mask:0xf bank_mask:0xf
  v_cndmask_b32_dpp v203, v236, v238, vcc quad_perm:[2,3,0,1] row_mask:0xf bank_mask:0xf
  v_cndmask_b32_dpp v204, v225, v227, vcc quad_perm:[2,3,0,1] row_mask:0xf bank_mask:0xf
  v_mfma_f32_32x32x16_bf16 v[56:71], v[136:139], v[188:191], v[56:71]
  ds_read_b64_tr_b16 v[136:137], v159 offset:36864
  ds_read_b64_tr_b16 v[138:139], v159 offset:37632
  buffer_load_dwordx4 v[168:171], v6, s[64:67], s22 offen offset:2048
  s_waitcnt lgkmcnt(12)
  v_mfma_f32_32x32x16_bf16 v[72:87], v[140:143], v[188:191], v[72:87]
  ds_read_b64_tr_b16 v[140:141], v159 offset:43008
  ds_read_b64_tr_b16 v[142:143], v159 offset:43776
  v_cndmask_b32_dpp v205, v229, v231, vcc quad_perm:[2,3,0,1] row_mask:0xf bank_mask:0xf
  v_cndmask_b32_dpp v206, v233, v235, vcc quad_perm:[2,3,0,1] row_mask:0xf bank_mask:0xf
  v_cndmask_b32_dpp v207, v237, v239, vcc quad_perm:[2,3,0,1] row_mask:0xf bank_mask:0xf
  v_mfma_f32_32x32x16_bf16 v[88:103], v[144:147], v[188:191], v[88:103]
  ds_read_b64_tr_b16 v[144:145], v8 offset:39936
  ds_read_b64_tr_b16 v[146:147], v8 offset:40704
  buffer_load_dwordx4 v4, s[60:63], s68 offen offset:1024 lds
  s_waitcnt vmcnt(9) lgkmcnt(12)
  v_mfma_f32_32x32x16_bf16 v[104:119], v[148:151], v[188:191], v[104:119]
  ds_read_b64_tr_b16 v[148:149], v8 offset:46080
  ds_read_b64_tr_b16 v[150:151], v8 offset:46848
  s_mov_b64 vcc, s[10:11]
  v_cndmask_b32_dpp v224, v212, v208, vcc quad_perm:[1,0,3,2] row_mask:0xf bank_mask:0xf
  v_cndmask_b32_dpp v226, v220, v216, vcc quad_perm:[1,0,3,2] row_mask:0xf bank_mask:0xf
  v_mfma_f32_32x32x16_bf16 v[24:39], v[120:123], v[192:195], v[24:39]
  ds_read_b64_tr_b16 v[120:121], v7 offset:39936
  ds_read_b64_tr_b16 v[122:123], v7 offset:40704
  buffer_load_dwordx4 v[172:175], v6, s[64:67], s22 offen offset:3072
  s_waitcnt lgkmcnt(12)
  v_mfma_f32_32x32x16_bf16 v[40:55], v[124:127], v[192:195], v[40:55]
  ds_read_b64_tr_b16 v[124:125], v7 offset:46080
  ds_read_b64_tr_b16 v[126:127], v7 offset:46848
  v_cndmask_b32_dpp v228, v213, v209, vcc quad_perm:[1,0,3,2] row_mask:0xf bank_mask:0xf
  v_cndmask_b32_dpp v230, v221, v217, vcc quad_perm:[1,0,3,2] row_mask:0xf bank_mask:0xf
  v_cndmask_b32_dpp v232, v214, v210, vcc quad_perm:[1,0,3,2] row_mask:0xf bank_mask:0xf
  v_mfma_f32_32x32x16_bf16 v[56:71], v[128:131], v[192:195], v[56:71]
  ds_read_b64_tr_b16 v[128:129], v159 offset:39936
  ds_read_b64_tr_b16 v[130:131], v159 offset:40704
  buffer_load_dwordx4 v5, s[60:63], s68 offen offset:2048 lds
  v_and_b32 v0, 0x1ff, v9
  s_waitcnt lgkmcnt(12)
  v_mfma_f32_32x32x16_bf16 v[72:87], v[132:135], v[192:195], v[72:87]
  ds_read_b64_tr_b16 v[132:133], v159 offset:46080
  ds_read_b64_tr_b16 v[134:135], v159 offset:46848
  v_cndmask_b32_dpp v234, v222, v218, vcc quad_perm:[1,0,3,2] row_mask:0xf bank_mask:0xf
  v_cndmask_b32_dpp v236, v215, v211, vcc quad_perm:[1,0,3,2] row_mask:0xf bank_mask:0xf
  v_cndmask_b32_dpp v238, v223, v219, vcc quad_perm:[1,0,3,2] row_mask:0xf bank_mask:0xf
  v_lshrrev_b32 v0, 1, v0
  v_mfma_f32_32x32x16_bf16 v[88:103], v[136:139], v[192:195], v[88:103]
  s_waitcnt vmcnt(10) lgkmcnt(10)
  s_barrier
  ds_read_b64_tr_b16 v[136:137], v8 offset:49152
  ds_read_b64_tr_b16 v[138:139], v8 offset:49920
  s_mul_i32 s68, s22, 1376
  s_add_u32 m0, s70, 24576
  buffer_load_dwordx2 v[10:11], v0, s[96:99], s44 offen sc1
  v_mfma_f32_32x32x16_bf16 v[104:119], v[140:143], v[192:195], v[104:119]
  ds_read_b64_tr_b16 v[140:141], v8 offset:55296
  ds_read_b64_tr_b16 v[142:143], v8 offset:56064
  s_not_b64 vcc, vcc
  v_cndmask_b32_dpp v225, v208, v212, vcc quad_perm:[1,0,3,2] row_mask:0xf bank_mask:0xf
  v_cndmask_b32_dpp v227, v216, v220, vcc quad_perm:[1,0,3,2] row_mask:0xf bank_mask:0xf
  v_mfma_f32_32x32x16_bf16 v[24:39], v[144:147], v[196:199], v[24:39]
  ds_read_b64_tr_b16 v[144:145], v7 offset:49152
  ds_read_b64_tr_b16 v[146:147], v7 offset:49920
  buffer_load_dwordx4 v3, s[60:63], s68 offen offset:0 lds
  s_waitcnt lgkmcnt(12)
  v_mfma_f32_32x32x16_bf16 v[40:55], v[148:151], v[196:199], v[40:55]
  ds_read_b64_tr_b16 v[148:149], v7 offset:55296
  ds_read_b64_tr_b16 v[150:151], v7 offset:56064
  v_cndmask_b32_dpp v229, v209, v213, vcc quad_perm:[1,0,3,2] row_mask:0xf bank_mask:0xf
  v_cndmask_b32_dpp v231, v217, v221, vcc quad_perm:[1,0,3,2] row_mask:0xf bank_mask:0xf
  v_cndmask_b32_dpp v233, v210, v214, vcc quad_perm:[1,0,3,2] row_mask:0xf bank_mask:0xf
  v_mfma_f32_32x32x16_bf16 v[56:71], v[120:123], v[196:199], v[56:71]
  ds_read_b64_tr_b16 v[120:121], v159 offset:49152
  ds_read_b64_tr_b16 v[122:123], v159 offset:49920
  buffer_load_dwordx4 v[176:179], v6, s[64:67], s23 offen offset:0
  s_waitcnt lgkmcnt(12)
  v_mfma_f32_32x32x16_bf16 v[72:87], v[124:127], v[196:199], v[72:87]
  ds_read_b64_tr_b16 v[124:125], v159 offset:55296
  ds_read_b64_tr_b16 v[126:127], v159 offset:56064
  v_cndmask_b32_dpp v235, v218, v222, vcc quad_perm:[1,0,3,2] row_mask:0xf bank_mask:0xf
  v_cndmask_b32_dpp v237, v211, v215, vcc quad_perm:[1,0,3,2] row_mask:0xf bank_mask:0xf
  v_cndmask_b32_dpp v239, v219, v223, vcc quad_perm:[1,0,3,2] row_mask:0xf bank_mask:0xf
  v_mfma_f32_32x32x16_bf16 v[88:103], v[128:131], v[196:199], v[88:103]
  ds_read_b64_tr_b16 v[128:129], v8 offset:52224
  ds_read_b64_tr_b16 v[130:131], v8 offset:52992
  buffer_load_dwordx4 v4, s[60:63], s68 offen offset:1024 lds
  s_waitcnt lgkmcnt(12)
  v_mfma_f32_32x32x16_bf16 v[104:119], v[132:135], v[196:199], v[104:119]
  ds_read_b64_tr_b16 v[132:133], v8 offset:58368
  ds_read_b64_tr_b16 v[134:135], v8 offset:59136
  s_mov_b64 vcc, s[12:13]
  v_cndmask_b32_dpp v208, v226, v224, vcc quad_perm:[2,3,0,1] row_mask:0xf bank_mask:0xf
  v_cndmask_b32_dpp v209, v230, v228, vcc quad_perm:[2,3,0,1] row_mask:0xf bank_mask:0xf
  v_mfma_f32_32x32x16_bf16 v[24:39], v[136:139], v[200:203], v[24:39]
  ds_read_b64_tr_b16 v[136:137], v7 offset:52224
  ds_read_b64_tr_b16 v[138:139], v7 offset:52992
  buffer_load_dwordx4 v[180:183], v6, s[64:67], s23 offen offset:1024
  s_waitcnt lgkmcnt(12)
  v_mfma_f32_32x32x16_bf16 v[40:55], v[140:143], v[200:203], v[40:55]
  ds_read_b64_tr_b16 v[140:141], v7 offset:58368
  ds_read_b64_tr_b16 v[142:143], v7 offset:59136
  v_cndmask_b32_dpp v210, v234, v232, vcc quad_perm:[2,3,0,1] row_mask:0xf bank_mask:0xf
  v_cndmask_b32_dpp v211, v238, v236, vcc quad_perm:[2,3,0,1] row_mask:0xf bank_mask:0xf
  v_cndmask_b32_dpp v212, v227, v225, vcc quad_perm:[2,3,0,1] row_mask:0xf bank_mask:0xf
  s_lshl1_add_u32 s4, s3, s45
  v_mfma_f32_32x32x16_bf16 v[56:71], v[144:147], v[200:203], v[56:71]
  ds_read_b64_tr_b16 v[144:145], v159 offset:52224
  ds_read_b64_tr_b16 v[146:147], v159 offset:52992
  buffer_load_dwordx4 v5, s[60:63], s68 offen offset:2048 lds
  s_waitcnt lgkmcnt(12)
  v_mfma_f32_32x32x16_bf16 v[72:87], v[148:151], v[200:203], v[72:87]
  ds_read_b64_tr_b16 v[148:149], v159 offset:58368
  ds_read_b64_tr_b16 v[150:151], v159 offset:59136
  v_cndmask_b32_dpp v213, v231, v229, vcc quad_perm:[2,3,0,1] row_mask:0xf bank_mask:0xf
  v_cndmask_b32_dpp v214, v235, v233, vcc quad_perm:[2,3,0,1] row_mask:0xf bank_mask:0xf
  v_cndmask_b32_dpp v215, v239, v237, vcc quad_perm:[2,3,0,1] row_mask:0xf bank_mask:0xf
  buffer_load_dwordx4 v[12:15], v9, s[96:99], s4 offen offset:0
  v_mfma_f32_32x32x16_bf16 v[88:103], v[120:123], v[200:203], v[88:103]
  s_waitcnt vmcnt(12) lgkmcnt(10)
  s_barrier
  ds_read_b64_tr_b16 v[120:121], v8 offset:0
  ds_read_b64_tr_b16 v[122:123], v8 offset:768
  s_add_u32 s68, s68, 44032
  s_add_u32 m0, s70, 36864
  buffer_load_dwordx4 v[16:19], v9, s[96:99], s4 offen offset:1024
  v_mfma_f32_32x32x16_bf16 v[104:119], v[124:127], v[200:203], v[104:119]
  ds_read_b64_tr_b16 v[124:125], v8 offset:6144
  ds_read_b64_tr_b16 v[126:127], v8 offset:6912
  s_not_b64 vcc, vcc
  v_cndmask_b32_dpp v216, v224, v226, vcc quad_perm:[2,3,0,1] row_mask:0xf bank_mask:0xf
  v_cndmask_b32_dpp v217, v228, v230, vcc quad_perm:[2,3,0,1] row_mask:0xf bank_mask:0xf
  buffer_load_dwordx4 v[20:23], v9, s[96:99], s4 offen offset:2048
  v_mfma_f32_32x32x16_bf16 v[24:39], v[128:131], v[204:207], v[24:39]
  ds_read_b64_tr_b16 v[128:129], v7 offset:0
  ds_read_b64_tr_b16 v[130:131], v7 offset:768
  buffer_load_dwordx4 v3, s[60:63], s68 offen offset:0 lds
  s_waitcnt lgkmcnt(12)
  v_mfma_f32_32x32x16_bf16 v[40:55], v[132:135], v[204:207], v[40:55]
  ds_read_b64_tr_b16 v[132:133], v7 offset:6144
  ds_read_b64_tr_b16 v[134:135], v7 offset:6912
  v_cndmask_b32_dpp v218, v232, v234, vcc quad_perm:[2,3,0,1] row_mask:0xf bank_mask:0xf
  v_cndmask_b32_dpp v219, v236, v238, vcc quad_perm:[2,3,0,1] row_mask:0xf bank_mask:0xf
  v_cndmask_b32_dpp v220, v225, v227, vcc quad_perm:[2,3,0,1] row_mask:0xf bank_mask:0xf
  buffer_load_dwordx4 v[240:243], v9, s[96:99], s4 offen offset:3072
  v_mfma_f32_32x32x16_bf16 v[56:71], v[136:139], v[204:207], v[56:71]
  ds_read_b64_tr_b16 v[136:137], v159 offset:0
  ds_read_b64_tr_b16 v[138:139], v159 offset:768
  buffer_load_dwordx4 v[184:187], v6, s[64:67], s23 offen offset:2048
  s_waitcnt lgkmcnt(12)
  v_mfma_f32_32x32x16_bf16 v[72:87], v[140:143], v[204:207], v[72:87]
  ds_read_b64_tr_b16 v[140:141], v159 offset:6144
  ds_read_b64_tr_b16 v[142:143], v159 offset:6912
  v_cndmask_b32_dpp v221, v229, v231, vcc quad_perm:[2,3,0,1] row_mask:0xf bank_mask:0xf
  v_cndmask_b32_dpp v222, v233, v235, vcc quad_perm:[2,3,0,1] row_mask:0xf bank_mask:0xf
  v_cndmask_b32_dpp v223, v237, v239, vcc quad_perm:[2,3,0,1] row_mask:0xf bank_mask:0xf
  v_mfma_f32_32x32x16_bf16 v[88:103], v[144:147], v[204:207], v[88:103]
  ds_read_b64_tr_b16 v[144:145], v8 offset:3072
  ds_read_b64_tr_b16 v[146:147], v8 offset:3840
  buffer_load_dwordx4 v4, s[60:63], s68 offen offset:1024 lds
  s_waitcnt vmcnt(14) lgkmcnt(12)
  v_mfma_f32_32x32x16_bf16 v[104:119], v[148:151], v[204:207], v[104:119]
  ds_read_b64_tr_b16 v[148:149], v8 offset:9216
  ds_read_b64_tr_b16 v[150:151], v8 offset:9984
  s_mov_b64 vcc, s[10:11]
  v_cndmask_b32_dpp v224, v164, v160, vcc quad_perm:[1,0,3,2] row_mask:0xf bank_mask:0xf
  v_cndmask_b32_dpp v226, v172, v168, vcc quad_perm:[1,0,3,2] row_mask:0xf bank_mask:0xf
  s_lshl1_add_u32 s5, s74, s45
  v_mfma_f32_32x32x16_bf16 v[24:39], v[120:123], v[208:211], v[24:39]
  ds_read_b64_tr_b16 v[120:121], v7 offset:3072
  ds_read_b64_tr_b16 v[122:123], v7 offset:3840
  buffer_load_dwordx4 v[188:191], v6, s[64:67], s23 offen offset:3072
  s_waitcnt lgkmcnt(12)
  v_mfma_f32_32x32x16_bf16 v[40:55], v[124:127], v[208:211], v[40:55]
  ds_read_b64_tr_b16 v[124:125], v7 offset:9216
  ds_read_b64_tr_b16 v[126:127], v7 offset:9984
  v_cndmask_b32_dpp v228, v165, v161, vcc quad_perm:[1,0,3,2] row_mask:0xf bank_mask:0xf
  v_cndmask_b32_dpp v230, v173, v169, vcc quad_perm:[1,0,3,2] row_mask:0xf bank_mask:0xf
  v_cndmask_b32_dpp v232, v166, v162, vcc quad_perm:[1,0,3,2] row_mask:0xf bank_mask:0xf
  buffer_load_dwordx4 v[244:247], v9, s[96:99], s5 offen offset:0
  v_mfma_f32_32x32x16_bf16 v[56:71], v[128:131], v[208:211], v[56:71]
  ds_read_b64_tr_b16 v[128:129], v159 offset:3072
  ds_read_b64_tr_b16 v[130:131], v159 offset:3840
  buffer_load_dwordx4 v5, s[60:63], s68 offen offset:2048 lds
  s_waitcnt lgkmcnt(12)
  v_mfma_f32_32x32x16_bf16 v[72:87], v[132:135], v[208:211], v[72:87]
  ds_read_b64_tr_b16 v[132:133], v159 offset:9216
  ds_read_b64_tr_b16 v[134:135], v159 offset:9984
  v_cndmask_b32_dpp v234, v174, v170, vcc quad_perm:[1,0,3,2] row_mask:0xf bank_mask:0xf
  v_cndmask_b32_dpp v236, v167, v163, vcc quad_perm:[1,0,3,2] row_mask:0xf bank_mask:0xf
  v_cndmask_b32_dpp v238, v175, v171, vcc quad_perm:[1,0,3,2] row_mask:0xf bank_mask:0xf
  buffer_load_dwordx4 v[248:251], v9, s[96:99], s5 offen offset:1024
  v_mfma_f32_32x32x16_bf16 v[88:103], v[136:139], v[208:211], v[88:103]
  s_waitcnt vmcnt(17) lgkmcnt(10)
  s_barrier
  ds_read_b64_tr_b16 v[136:137], v8 offset:12288
  ds_read_b64_tr_b16 v[138:139], v8 offset:13056
  s_mul_i32 s68, s23, 1376
  s_add_u32 m0, s70, 49152
  buffer_load_dwordx4 v[252:255], v9, s[96:99], s5 offen offset:2048
  v_mfma_f32_32x32x16_bf16 v[104:119], v[140:143], v[208:211], v[104:119]
  ds_read_b64_tr_b16 v[140:141], v8 offset:18432
  ds_read_b64_tr_b16 v[142:143], v8 offset:19200
  s_not_b64 vcc, vcc
  v_cndmask_b32_dpp v225, v160, v164, vcc quad_perm:[1,0,3,2] row_mask:0xf bank_mask:0xf
  v_cndmask_b32_dpp v227, v168, v172, vcc quad_perm:[1,0,3,2] row_mask:0xf bank_mask:0xf
  buffer_load_dwordx4 v[192:195], v9, s[96:99], s5 offen offset:3072
  v_mfma_f32_32x32x16_bf16 v[24:39], v[144:147], v[212:215], v[24:39]
  ds_read_b64_tr_b16 v[144:145], v7 offset:12288
  ds_read_b64_tr_b16 v[146:147], v7 offset:13056
  buffer_load_dwordx4 v3, s[60:63], s68 offen offset:0 lds
  s_waitcnt lgkmcnt(12)
  v_mfma_f32_32x32x16_bf16 v[40:55], v[148:151], v[212:215], v[40:55]
  ds_read_b64_tr_b16 v[148:149], v7 offset:18432
  ds_read_b64_tr_b16 v[150:151], v7 offset:19200
  v_cndmask_b32_dpp v229, v161, v165, vcc quad_perm:[1,0,3,2] row_mask:0xf bank_mask:0xf
  v_cndmask_b32_dpp v231, v169, v173, vcc quad_perm:[1,0,3,2] row_mask:0xf bank_mask:0xf
  v_cndmask_b32_dpp v233, v162, v166, vcc quad_perm:[1,0,3,2] row_mask:0xf bank_mask:0xf
  s_lshl1_add_u32 s6, s75, s45
  v_mfma_f32_32x32x16_bf16 v[56:71], v[120:123], v[212:215], v[56:71]
  ds_read_b64_tr_b16 v[120:121], v159 offset:12288
  ds_read_b64_tr_b16 v[122:123], v159 offset:13056
  buffer_load_dwordx4 v[196:199], v9, s[96:99], s6 offen offset:0
  s_waitcnt lgkmcnt(12)
  v_mfma_f32_32x32x16_bf16 v[72:87], v[124:127], v[212:215], v[72:87]
  ds_read_b64_tr_b16 v[124:125], v159 offset:18432
  ds_read_b64_tr_b16 v[126:127], v159 offset:19200
  v_cndmask_b32_dpp v235, v170, v174, vcc quad_perm:[1,0,3,2] row_mask:0xf bank_mask:0xf
  v_cndmask_b32_dpp v237, v163, v167, vcc quad_perm:[1,0,3,2] row_mask:0xf bank_mask:0xf
  v_cndmask_b32_dpp v239, v171, v175, vcc quad_perm:[1,0,3,2] row_mask:0xf bank_mask:0xf
  buffer_load_dwordx4 v[200:203], v9, s[96:99], s6 offen offset:1024
  v_mfma_f32_32x32x16_bf16 v[88:103], v[128:131], v[212:215], v[88:103]
  ds_read_b64_tr_b16 v[128:129], v8 offset:15360
  ds_read_b64_tr_b16 v[130:131], v8 offset:16128
  buffer_load_dwordx4 v4, s[60:63], s68 offen offset:1024 lds
  s_waitcnt lgkmcnt(12)
  v_mfma_f32_32x32x16_bf16 v[104:119], v[132:135], v[212:215], v[104:119]
  ds_read_b64_tr_b16 v[132:133], v8 offset:21504
  ds_read_b64_tr_b16 v[134:135], v8 offset:22272
  s_mov_b64 vcc, s[12:13]
  v_cndmask_b32_dpp v160, v226, v224, vcc quad_perm:[2,3,0,1] row_mask:0xf bank_mask:0xf
  v_cndmask_b32_dpp v161, v230, v228, vcc quad_perm:[2,3,0,1] row_mask:0xf bank_mask:0xf
  buffer_load_dwordx4 v[204:207], v9, s[96:99], s6 offen offset:2048
  v_mfma_f32_32x32x16_bf16 v[24:39], v[136:139], v[216:219], v[24:39]
  ds_read_b64_tr_b16 v[136:137], v7 offset:15360
  ds_read_b64_tr_b16 v[138:139], v7 offset:16128
  s_waitcnt lgkmcnt(12)
  v_mfma_f32_32x32x16_bf16 v[40:55], v[140:143], v[216:219], v[40:55]
  ds_read_b64_tr_b16 v[140:141], v7 offset:21504
  ds_read_b64_tr_b16 v[142:143], v7 offset:22272
  v_cndmask_b32_dpp v162, v234, v232, vcc quad_perm:[2,3,0,1] row_mask:0xf bank_mask:0xf
  v_cndmask_b32_dpp v163, v238, v236, vcc quad_perm:[2,3,0,1] row_mask:0xf bank_mask:0xf
  v_cndmask_b32_dpp v164, v227, v225, vcc quad_perm:[2,3,0,1] row_mask:0xf bank_mask:0xf
  v_mfma_f32_32x32x16_bf16 v[56:71], v[144:147], v[216:219], v[56:71]
  ds_read_b64_tr_b16 v[144:145], v159 offset:15360
  ds_read_b64_tr_b16 v[146:147], v159 offset:16128
  buffer_load_dwordx4 v5, s[60:63], s68 offen offset:2048 lds
  s_waitcnt lgkmcnt(12)
  v_mfma_f32_32x32x16_bf16 v[72:87], v[148:151], v[216:219], v[72:87]
  ds_read_b64_tr_b16 v[148:149], v159 offset:21504
  ds_read_b64_tr_b16 v[150:151], v159 offset:22272
  v_cndmask_b32_dpp v165, v231, v229, vcc quad_perm:[2,3,0,1] row_mask:0xf bank_mask:0xf
  v_cndmask_b32_dpp v166, v235, v233, vcc quad_perm:[2,3,0,1] row_mask:0xf bank_mask:0xf
  v_cndmask_b32_dpp v167, v239, v237, vcc quad_perm:[2,3,0,1] row_mask:0xf bank_mask:0xf
  v_mfma_f32_32x32x16_bf16 v[88:103], v[120:123], v[216:219], v[88:103]
  s_waitcnt vmcnt(19) lgkmcnt(10)
  s_barrier
  ds_read_b64_tr_b16 v[120:121], v8 offset:24576
  ds_read_b64_tr_b16 v[122:123], v8 offset:25344
  s_add_u32 s68, s68, 44032
  s_add_u32 m0, s70, 0
  v_mfma_f32_32x32x16_bf16 v[104:119], v[124:127], v[216:219], v[104:119]
  ds_read_b64_tr_b16 v[124:125], v8 offset:30720
  ds_read_b64_tr_b16 v[126:127], v8 offset:31488
  s_not_b64 vcc, vcc
  v_cndmask_b32_dpp v168, v224, v226, vcc quad_perm:[2,3,0,1] row_mask:0xf bank_mask:0xf
  v_cndmask_b32_dpp v169, v228, v230, vcc quad_perm:[2,3,0,1] row_mask:0xf bank_mask:0xf
  v_mfma_f32_32x32x16_bf16 v[24:39], v[128:131], v[220:223], v[24:39]
  ds_read_b64_tr_b16 v[128:129], v7 offset:24576
  ds_read_b64_tr_b16 v[130:131], v7 offset:25344
  buffer_load_dwordx4 v3, s[60:63], s68 offen offset:0 lds
  s_waitcnt lgkmcnt(12)
  v_mfma_f32_32x32x16_bf16 v[40:55], v[132:135], v[220:223], v[40:55]
  ds_read_b64_tr_b16 v[132:133], v7 offset:30720
  ds_read_b64_tr_b16 v[134:135], v7 offset:31488
  v_cndmask_b32_dpp v170, v232, v234, vcc quad_perm:[2,3,0,1] row_mask:0xf bank_mask:0xf
  v_cndmask_b32_dpp v171, v236, v238, vcc quad_perm:[2,3,0,1] row_mask:0xf bank_mask:0xf
  v_cndmask_b32_dpp v172, v225, v227, vcc quad_perm:[2,3,0,1] row_mask:0xf bank_mask:0xf
  v_mfma_f32_32x32x16_bf16 v[56:71], v[136:139], v[220:223], v[56:71]
  ds_read_b64_tr_b16 v[136:137], v159 offset:24576
  ds_read_b64_tr_b16 v[138:139], v159 offset:25344
  v_cmp_ne_u32_e64 s[100:101], s38, v11
  s_cmp_eq_u64 s[100:101], 0
  s_cbranch_scc1 EXTD_4
  s_mov_b32 s43, 4000
EXT_3:
  v_and_b32 v0, 0x1ff, v9
  v_lshrrev_b32 v0, 1, v0
  buffer_load_dwordx2 v[10:11], v0, s[96:99], s44 offen sc1
  s_waitcnt vmcnt(0)
  v_cmp_ne_u32_e64 s[100:101], s38, v11
  s_cmp_eq_u64 s[100:101], 0
  s_cbranch_scc1 EXTD_4
  s_sub_u32 s43, s43, 1
  s_cmp_lg_u32 s43, 0
  s_cbranch_scc1 EXT_3
EXTD_4:
  s_waitcnt lgkmcnt(12)
  v_mfma_f32_32x32x16_bf16 v[72:87], v[140:143], v[220:223], v[72:87]
  ds_read_b64_tr_b16 v[140:141], v159 offset:30720
  ds_read_b64_tr_b16 v[142:143], v159 offset:31488
  v_cndmask_b32_dpp v173, v229, v231, vcc quad_perm:[2,3,0,1] row_mask:0xf bank_mask:0xf
  v_cndmask_b32_dpp v174, v233, v235, vcc quad_perm:[2,3,0,1] row_mask:0xf bank_mask:0xf
  v_cndmask_b32_dpp v175, v237, v239, vcc quad_perm:[2,3,0,1] row_mask:0xf bank_mask:0xf
  v_mfma_f32_32x32x16_bf16 v[88:103], v[144:147], v[220:223], v[88:103]
  ds_read_b64_tr_b16 v[144:145], v8 offset:27648
  ds_read_b64_tr_b16 v[146:147], v8 offset:28416
  buffer_load_dwordx4 v4, s[60:63], s68 offen offset:1024 lds
  s_waitcnt vmcnt(13) lgkmcnt(12)
  v_mfma_f32_32x32x16_bf16 v[104:119], v[148:151], v[220:223], v[104:119]
  ds_read_b64_tr_b16 v[148:149], v8 offset:33792
  ds_read_b64_tr_b16 v[150:151], v8 offset:34560
  s_mov_b64 vcc, s[10:11]
  v_cndmask_b32_dpp v224, v180, v176, vcc quad_perm:[1,0,3,2] row_mask:0xf bank_mask:0xf
  v_cndmask_b32_dpp v226, v188, v184, vcc quad_perm:[1,0,3,2] row_mask:0xf bank_mask:0xf
  v_mfma_f32_32x32x16_bf16 v[24:39], v[120:123], v[160:163], v[24:39]
  ds_read_b64_tr_b16 v[120:121], v7 offset:27648
  ds_read_b64_tr_b16 v[122:123], v7 offset:28416
  buffer_load_dwordx4 v[208:211], v9, s[96:99], s6 offen offset:3072
  s_waitcnt lgkmcnt(12)
  v_mfma_f32_32x32x16_bf16 v[40:55], v[124:127], v[160:163], v[40:55]
  ds_read_b64_tr_b16 v[124:125], v7 offset:33792
  ds_read_b64_tr_b16 v[126:127], v7 offset:34560
  v_cndmask_b32_dpp v228, v181, v177, vcc quad_perm:[1,0,3,2] row_mask:0xf bank_mask:0xf
  v_cndmask_b32_dpp v230, v189, v185, vcc quad_perm:[1,0,3,2] row_mask:0xf bank_mask:0xf
  v_cndmask_b32_dpp v232, v182, v178, vcc quad_perm:[1,0,3,2] row_mask:0xf bank_mask:0xf
  s_mov_b32 s43, 0x01000100
  v_mfma_f32_32x32x16_bf16 v[56:71], v[128:131], v[160:163], v[56:71]
  ds_read_b64_tr_b16 v[128:129], v159 offset:27648
  ds_read_b64_tr_b16 v[130:131], v159 offset:28416
  buffer_load_dwordx4 v5, s[60:63], s68 offen offset:2048 lds
  v_perm_b32 v212, v10, v10, s43
  s_waitcnt lgkmcnt(12)
  v_mfma_f32_32x32x16_bf16 v[72:87], v[132:135], v[160:163], v[72:87]
  ds_read_b64_tr_b16 v[132:133], v159 offset:33792
  ds_read_b64_tr_b16 v[134:135], v159 offset:34560
  v_cndmask_b32_dpp v234, v190, v186, vcc quad_perm:[1,0,3,2] row_mask:0xf bank_mask:0xf
  v_cndmask_b32_dpp v236, v183, v179, vcc quad_perm:[1,0,3,2] row_mask:0xf bank_mask:0xf
  v_cndmask_b32_dpp v238, v191, v187, vcc quad_perm:[1,0,3,2] row_mask:0xf bank_mask:0xf
  v_xor_b32 v212, 0x80008000, v212
  v_mfma_f32_32x32x16_bf16 v[88:103], v[136:139], v[160:163], v[88:103]
  s_waitcnt vmcnt(13) lgkmcnt(10)
  s_barrier
  ds_read_b64_tr_b16 v[136:137], v8 offset:36864
  ds_read_b64_tr_b16 v[138:139], v8 offset:37632
  v_mov_b32 v213, 0
  v_mfma_f32_32x32x16_bf16 v[104:119], v[140:143], v[160:163], v[104:119]
  ds_read_b64_tr_b16 v[140:141], v8 offset:43008
  ds_read_b64_tr_b16 v[142:143], v8 offset:43776
  s_not_b64 vcc, vcc
  v_cndmask_b32_dpp v225, v176, v180, vcc quad_perm:[1,0,3,2] row_mask:0xf bank_mask:0xf
  v_cndmask_b32_dpp v227, v184, v188, vcc quad_perm:[1,0,3,2] row_mask:0xf bank_mask:0xf
  v_mov_b32 v214, v212
  v_mfma_f32_32x32x16_bf16 v[24:39], v[144:147], v[164:167], v[24:39]
  ds_read_b64_tr_b16 v[144:145], v7 offset:36864
  ds_read_b64_tr_b16 v[146:147], v7 offset:37632
  v_mov_b32 v215, 0
  s_add_u32 s50, s14, 65536
  s_add_u32 m0, s69, 65536
  s_waitcnt lgkmcnt(12)
  v_mfma_f32_32x32x16_bf16 v[40:55], v[148:151], v[164:167], v[40:55]
  ds_read_b64_tr_b16 v[148:149], v7 offset:43008
  ds_read_b64_tr_b16 v[150:151], v7 offset:43776
  v_cndmask_b32_dpp v229, v177, v181, vcc quad_perm:[1,0,3,2] row_mask:0xf bank_mask:0xf
  v_cndmask_b32_dpp v231, v185, v189, vcc quad_perm:[1,0,3,2] row_mask:0xf bank_mask:0xf
  v_cndmask_b32_dpp v233, v178, v182, vcc quad_perm:[1,0,3,2] row_mask:0xf bank_mask:0xf
  v_mfma_f32_32x32x16_bf16 v[56:71], v[120:123], v[164:167], v[56:71]
  ds_read_b64_tr_b16 v[120:121], v159 offset:36864
  ds_read_b64_tr_b16 v[122:123], v159 offset:37632
  buffer_load_dwordx4 v152, s[56:59], s50 offen offset:0 lds
  s_waitcnt lgkmcnt(12)
  v_mfma_f32_32x32x16_bf16 v[72:87], v[124:127], v[164:167], v[72:87]
  ds_read_b64_tr_b16 v[124:125], v159 offset:43008
  ds_read_b64_tr_b16 v[126:127], v159 offset:43776
  v_cndmask_b32_dpp v235, v186, v190, vcc quad_perm:[1,0,3,2] row_mask:0xf bank_mask:0xf
  v_cndmask_b32_dpp v237, v179, v183, vcc quad_perm:[1,0,3,2] row_mask:0xf bank_mask:0xf
  v_cndmask_b32_dpp v239, v187, v191, vcc quad_perm:[1,0,3,2] row_mask:0xf bank_mask:0xf
  v_mfma_f32_32x32x16_bf16 v[88:103], v[128:131], v[164:167], v[88:103]
  ds_read_b64_tr_b16 v[128:129], v8 offset:39936
  ds_read_b64_tr_b16 v[130:131], v8 offset:40704
  buffer_load_dwordx4 v153, s[56:59], s50 offen offset:1024 lds
  s_waitcnt lgkmcnt(12)
  v_mfma_f32_32x32x16_bf16 v[104:119], v[132:135], v[164:167], v[104:119]
  ds_read_b64_tr_b16 v[132:133], v8 offset:46080
  ds_read_b64_tr_b16 v[134:135], v8 offset:46848
  s_mov_b64 vcc, s[12:13]
  v_cndmask_b32_dpp v176, v226, v224, vcc quad_perm:[2,3,0,1] row_mask:0xf bank_mask:0xf
  v_cndmask_b32_dpp v177, v230, v228, vcc quad_perm:[2,3,0,1] row_mask:0xf bank_mask:0xf
  v_mfma_f32_32x32x16_bf16 v[24:39], v[136:139], v[168:171], v[24:39]
  ds_read_b64_tr_b16 v[136:137], v7 offset:39936
  ds_read_b64_tr_b16 v[138:139], v7 offset:40704
  buffer_load_dwordx4 v154, s[56:59], s50 offen offset:2048 lds
  s_waitcnt lgkmcnt(12)
  v_mfma_f32_32x32x16_bf16 v[40:55], v[140:143], v[168:171], v[40:55]
  ds_read_b64_tr_b16 v[140:141], v7 offset:46080
  ds_read_b64_tr_b16 v[142:143], v7 offset:46848
  v_cndmask_b32_dpp v178, v234, v232, vcc quad_perm:[2,3,0,1] row_mask:0xf bank_mask:0xf
  v_cndmask_b32_dpp v179, v238, v236, vcc quad_perm:[2,3,0,1] row_mask:0xf bank_mask:0xf
  v_cndmask_b32_dpp v180, v227, v225, vcc quad_perm:[2,3,0,1] row_mask:0xf bank_mask:0xf
  v_mfma_f32_32x32x16_bf16 v[56:71], v[144:147], v[168:171], v[56:71]
  ds_read_b64_tr_b16 v[144:145], v159 offset:39936
  ds_read_b64_tr_b16 v[146:147], v159 offset:40704
  buffer_load_dwordx4 v155, s[56:59], s50 offen offset:3072 lds
  s_waitcnt lgkmcnt(12)
  v_mfma_f32_32x32x16_bf16 v[72:87], v[148:151], v[168:171], v[72:87]
  ds_read_b64_tr_b16 v[148:149], v159 offset:46080
  ds_read_b64_tr_b16 v[150:151], v159 offset:46848
  v_cndmask_b32_dpp v181, v231, v229, vcc quad_perm:[2,3,0,1] row_mask:0xf bank_mask:0xf
  v_cndmask_b32_dpp v182, v235, v233, vcc quad_perm:[2,3,0,1] row_mask:0xf bank_mask:0xf
  v_cndmask_b32_dpp v183, v239, v237, vcc quad_perm:[2,3,0,1] row_mask:0xf bank_mask:0xf
  v_mfma_f32_32x32x16_bf16 v[88:103], v[120:123], v[168:171], v[88:103]
  s_waitcnt vmcnt(4) lgkmcnt(10)
  s_barrier
  ds_read_b64_tr_b16 v[120:121], v8 offset:49152
  ds_read_b64_tr_b16 v[122:123], v8 offset:49920
  v_mfma_f32_32x32x16_bf16 v[104:119], v[124:127], v[168:171], v[104:119]
  ds_read_b64_tr_b16 v[124:125], v8 offset:55296
  ds_read_b64_tr_b16 v[126:127], v8 offset:56064
  s_not_b64 vcc, vcc
  v_cndmask_b32_dpp v184, v224, v226, vcc quad_perm:[2,3,0,1] row_mask:0xf bank_mask:0xf
  v_cndmask_b32_dpp v185, v228, v230, vcc quad_perm:[2,3,0,1] row_mask:0xf bank_mask:0xf
  s_add_u32 s50, s14, 98304
  v_mfma_f32_32x32x16_bf16 v[24:39], v[128:131], v[172:175], v[24:39]
  ds_read_b64_tr_b16 v[128:129], v8 offset:52224
  ds_read_b64_tr_b16 v[130:131], v8 offset:52992
  s_add_u32 m0, s69, 16384
  s_waitcnt lgkmcnt(12)
  v_mfma_f32_32x32x16_bf16 v[40:55], v[132:135], v[172:175], v[40:55]
  ds_read_b64_tr_b16 v[132:133], v8 offset:58368
  ds_read_b64_tr_b16 v[134:135], v8 offset:59136
  v_cndmask_b32_dpp v186, v232, v234, vcc quad_perm:[2,3,0,1] row_mask:0xf bank_mask:0xf
  v_cndmask_b32_dpp v187, v236, v238, vcc quad_perm:[2,3,0,1] row_mask:0xf bank_mask:0xf
  v_cndmask_b32_dpp v188, v225, v227, vcc quad_perm:[2,3,0,1] row_mask:0xf bank_mask:0xf
  v_mfma_f32_32x32x16_bf16 v[56:71], v[136:139], v[172:175], v[56:71]
  ds_read_b64_tr_b16 v[136:137], v8 offset:0
  ds_read_b64_tr_b16 v[138:139], v8 offset:768
  buffer_load_dwordx4 v152, s[56:59], s50 offen offset:0 lds
  s_waitcnt lgkmcnt(12)
  v_mfma_f32_32x32x16_bf16 v[72:87], v[140:143], v[172:175], v[72:87]
  ds_read_b64_tr_b16 v[140:141], v8 offset:6144
  ds_read_b64_tr_b16 v[142:143], v8 offset:6912
  v_cndmask_b32_dpp v189, v229, v231, vcc quad_perm:[2,3,0,1] row_mask:0xf bank_mask:0xf
  v_cndmask_b32_dpp v190, v233, v235, vcc quad_perm:[2,3,0,1] row_mask:0xf bank_mask:0xf
  v_cndmask_b32_dpp v191, v237, v239, vcc quad_perm:[2,3,0,1] row_mask:0xf bank_mask:0xf
  v_mfma_f32_32x32x16_bf16 v[88:103], v[144:147], v[172:175], v[88:103]
  ds_read_b64_tr_b16 v[144:145], v8 offset:3072
  ds_read_b64_tr_b16 v[146:147], v8 offset:3840
  buffer_load_dwordx4 v153, s[56:59], s50 offen offset:1024 lds
  s_waitcnt lgkmcnt(12)
  v_mfma_f32_32x32x16_bf16 v[104:119], v[148:151], v[172:175], v[104:119]
  ds_read_b64_tr_b16 v[148:149], v8 offset:9216
  ds_read_b64_tr_b16 v[150:151], v8 offset:9984
  s_waitcnt lgkmcnt(12)
  v_mfma_f32_32x32x16_bf16 v[24:39], v[120:123], v[176:179], v[24:39]
  v_min3_u32 v0, v13, v15, v17
  v_max3_u32 v1, v13, v15, v17
  buffer_load_dwordx4 v154, s[56:59], s50 offen offset:2048 lds
  v_mfma_f32_32x32x16_bf16 v[40:55], v[124:127], v[176:179], v[40:55]
  v_min3_u32 v0, v0, v19, v21
  buffer_load_dwordx4 v155, s[56:59], s50 offen offset:3072 lds
  s_waitcnt lgkmcnt(8)
  v_mfma_f32_32x32x16_bf16 v[24:39], v[128:131], v[180:183], v[24:39]
  s_barrier
  v_max3_u32 v1, v1, v19, v21
  v_mfma_f32_32x32x16_bf16 v[40:55], v[132:135], v[180:183], v[40:55]
  v_min3_u32 v0, v0, v23, v241
  s_add_u32 s50, s14, 131072
  s_add_u32 m0, s69, 32768
  s_waitcnt lgkmcnt(4)
  v_mfma_f32_32x32x16_bf16 v[24:39], v[136:139], v[184:187], v[24:39]
  ds_read_b64_tr_b16 v[120:121], v7 offset:49152
  ds_read_b64_tr_b16 v[122:123], v7 offset:49920
  v_max3_u32 v1, v1, v23, v241
  buffer_load_dwordx4 v152, s[56:59], s50 offen offset:0 lds
  v_mfma_f32_32x32x16_bf16 v[40:55], v[140:143], v[184:187], v[40:55]
  ds_read_b64_tr_b16 v[124:125], v7 offset:55296
  ds_read_b64_tr_b16 v[126:127], v7 offset:56064
  v_min_u32 v0, v0, v243
  s_waitcnt lgkmcnt(4)
  v_mfma_f32_32x32x16_bf16 v[24:39], v[144:147], v[188:191], v[24:39]
  ds_read_b64_tr_b16 v[128:129], v7 offset:52224
  ds_read_b64_tr_b16 v[130:131], v7 offset:52992
  v_max_u32 v1, v1, v243
  buffer_load_dwordx4 v153, s[56:59], s50 offen offset:1024 lds
  v_mfma_f32_32x32x16_bf16 v[40:55], v[148:151], v[188:191], v[40:55]
  ds_read_b64_tr_b16 v[132:133], v7 offset:58368
  ds_read_b64_tr_b16 v[134:135], v7 offset:59136
  v_cmp_ne_u32 vcc, s38, v0
  v_cmp_ne_u32_e64 s[100:101], s38, v1
  s_or_b64 vcc, vcc, s[100:101]
  s_cbranch_vccz CSD_6
  s_mov_b32 s43, 4000
CS_5:
  s_lshl1_add_u32 s4, s3, s45
  buffer_load_dwordx4 v[12:15], v9, s[96:99], s4 offen offset:0 sc1
  buffer_load_dwordx4 v[16:19], v9, s[96:99], s4 offen offset:1024 sc1
  buffer_load_dwordx4 v[20:23], v9, s[96:99], s4 offen offset:2048 sc1
  buffer_load_dwordx4 v[240:243], v9, s[96:99], s4 offen offset:3072 sc1
  s_waitcnt vmcnt(0)
  v_min3_u32 v0, v13, v15, v17
  v_max3_u32 v1, v13, v15, v17
  v_min3_u32 v0, v0, v19, v21
  v_max3_u32 v1, v1, v19, v21
  v_min3_u32 v0, v0, v23, v241
  v_max3_u32 v1, v1, v23, v241
  v_min_u32 v0, v0, v243
  v_max_u32 v1, v1, v243
  v_cmp_ne_u32 vcc, s38, v0
  v_cmp_ne_u32_e64 s[100:101], s38, v1
  s_or_b64 vcc, vcc, s[100:101]
  s_cbranch_vccz CSD_6
  s_sub_u32 s43, s43, 1
  s_cmp_lg_u32 s43, 0
  s_cbranch_scc1 CS_5
CSD_6:
  v_mfma_f32_32x32x16_bf16 v[24:39], v[12:15], v[212:215], v[24:39]
  ds_read_b64_tr_b16 v[136:137], v7 offset:0
  ds_read_b64_tr_b16 v[138:139], v7 offset:768
  buffer_load_dwordx4 v154, s[56:59], s50 offen offset:2048 lds
  v_mfma_f32_32x32x16_bf16 v[40:55], v[20:23], v[212:215], v[40:55]
  ds_read_b64_tr_b16 v[140:141], v7 offset:6144
  ds_read_b64_tr_b16 v[142:143], v7 offset:6912
  buffer_load_dwordx4 v155, s[56:59], s50 offen offset:3072 lds
  v_mfma_f32_32x32x16_bf16 v[24:39], v[16:19], v[212:215], v[24:39]
  ds_read_b64_tr_b16 v[144:145], v7 offset:3072
  ds_read_b64_tr_b16 v[146:147], v7 offset:3840
  v_mfma_f32_32x32x16_bf16 v[40:55], v[240:243], v[212:215], v[40:55]
  ds_read_b64_tr_b16 v[148:149], v7 offset:9216
  ds_read_b64_tr_b16 v[150:151], v7 offset:9984
  s_waitcnt lgkmcnt(12)
  v_mfma_f32_32x32x16_bf16 v[56:71], v[120:123], v[176:179], v[56:71]
  v_min3_u32 v0, v245, v247, v249
  v_max3_u32 v1, v245, v247, v249
  v_mfma_f32_32x32x16_bf16 v[72:87], v[124:127], v[176:179], v[72:87]
  v_min3_u32 v0, v0, v251, v253
  s_add_u32 s39, s48, s3
  s_nop 2
  v_mul_f32 v24, v24, v40
  v_mul_f32 v25, v25, v41
  v_mul_f32 v26, v26, v42
  s_waitcnt lgkmcnt(8)
  v_mfma_f32_32x32x16_bf16 v[56:71], v[128:131], v[180:183], v[56:71]
  v_max3_u32 v1, v1, v251, v253
  v_mul_f32 v27, v27, v43
  v_mul_f32 v28, v28, v44
  v_mul_f32 v29, v29, v45
  v_mul_f32 v30, v30, v46
  v_mul_f32 v31, v31, v47
  v_mfma_f32_32x32x16_bf16 v[72:87], v[132:135], v[180:183], v[72:87]
  v_min3_u32 v0, v0, v255, v193
  v_mul_f32 v32, v32, v48
  v_mul_f32 v33, v33, v49
  v_mul_f32 v34, v34, v50
  v_mul_f32 v35, v35, v51
  s_waitcnt lgkmcnt(4)
  v_mfma_f32_32x32x16_bf16 v[56:71], v[136:139], v[184:187], v[56:71]
  ds_read_b64_tr_b16 v[120:121], v159 offset:49152
  ds_read_b64_tr_b16 v[122:123], v159 offset:49920
  v_max3_u32 v1, v1, v255, v193
  v_mul_f32 v36, v36, v52
  v_mul_f32 v37, v37, v53
  v_mul_f32 v38, v38, v54
  v_mfma_f32_32x32x16_bf16 v[72:87], v[140:143], v[184:187], v[72:87]
  ds_read_b64_tr_b16 v[124:125], v159 offset:55296
  ds_read_b64_tr_b16 v[126:127], v159 offset:56064
  v_min_u32 v0, v0, v195
  v_mul_f32 v39, v39, v55
  v_cvt_pk_bf16_f32 v40, v24, v25
  s_waitcnt lgkmcnt(4)
  v_mfma_f32_32x32x16_bf16 v[56:71], v[144:147], v[188:191], v[56:71]
  ds_read_b64_tr_b16 v[128:129], v159 offset:52224
  ds_read_b64_tr_b16 v[130:131], v159 offset:52992
  v_max_u32 v1, v1, v195
  v_cvt_pk_bf16_f32 v41, v26, v27
  v_cvt_pk_bf16_f32 v42, v28, v29
  v_cvt_pk_bf16_f32 v43, v30, v31
  v_mfma_f32_32x32x16_bf16 v[72:87], v[148:151], v[188:191], v[72:87]
  ds_read_b64_tr_b16 v[132:133], v159 offset:58368
  ds_read_b64_tr_b16 v[134:135], v159 offset:59136
  v_cmp_ne_u32 vcc, s38, v0
  v_cmp_ne_u32_e64 s[100:101], s38, v1
  s_or_b64 vcc, vcc, s[100:101]
  s_cbranch_vccz CSD_9
  s_mov_b32 s43, 4000
CS_8:
  s_lshl1_add_u32 s5, s74, s45
  buffer_load_dwordx4 v[244:247], v9, s[96:99], s5 offen offset:0 sc1
  buffer_load_dwordx4 v[248:251], v9, s[96:99], s5 offen offset:1024 sc1
  buffer_load_dwordx4 v[252:255], v9, s[96:99], s5 offen offset:2048 sc1
  buffer_load_dwordx4 v[192:195], v9, s[96:99], s5 offen offset:3072 sc1
  s_waitcnt vmcnt(0)
  v_min3_u32 v0, v245, v247, v249
  v_max3_u32 v1, v245, v247, v249
  v_min3_u32 v0, v0, v251, v253
  v_max3_u32 v1, v1, v251, v253
  v_min3_u32 v0, v0, v255, v193
  v_max3_u32 v1, v1, v255, v193
  v_min_u32 v0, v0, v195
  v_max_u32 v1, v1, v195
  v_cmp_ne_u32 vcc, s38, v0
  v_cmp_ne_u32_e64 s[100:101], s38, v1
  s_or_b64 vcc, vcc, s[100:101]
  s_cbranch_vccz CSD_9
  s_sub_u32 s43, s43, 1
  s_cmp_lg_u32 s43, 0
  s_cbranch_scc1 CS_8
CSD_9:
  v_mfma_f32_32x32x16_bf16 v[56:71], v[244:247], v[212:215], v[56:71]
  ds_read_b64_tr_b16 v[136:137], v159 offset:0
  ds_read_b64_tr_b16 v[138:139], v159 offset:768
  buffer_store_dwordx4 v[40:43], v9, s[96:99], s39 offen offset:0 sc1
  v_cvt_pk_bf16_f32 v44, v32, v33
  v_mfma_f32_32x32x16_bf16 v[72:87], v[252:255], v[212:215], v[72:87]
  ds_read_b64_tr_b16 v[140:141], v159 offset:6144
  ds_read_b64_tr_b16 v[142:143], v159 offset:6912
  v_cvt_pk_bf16_f32 v45, v34, v35
  v_cvt_pk_bf16_f32 v46, v36, v37
  v_cvt_pk_bf16_f32 v47, v38, v39
  v_mfma_f32_32x32x16_bf16 v[56:71], v[248:251], v[212:215], v[56:71]
  ds_read_b64_tr_b16 v[144:145], v159 offset:3072
  ds_read_b64_tr_b16 v[146:147], v159 offset:3840
  buffer_store_dwordx4 v[44:47], v9, s[96:99], s39 offen offset:1024 sc1
  v_mfma_f32_32x32x16_bf16 v[72:87], v[192:195], v[212:215], v[72:87]
  ds_read_b64_tr_b16 v[148:149], v159 offset:9216
  ds_read_b64_tr_b16 v[150:151], v159 offset:9984
  s_waitcnt lgkmcnt(12)
  v_mfma_f32_32x32x16_bf16 v[88:103], v[120:123], v[176:179], v[88:103]
  v_min3_u32 v0, v197, v199, v201
  v_max3_u32 v1, v197, v199, v201
  v_mfma_f32_32x32x16_bf16 v[104:119], v[124:127], v[176:179], v[104:119]
  v_min3_u32 v0, v0, v203, v205
  s_add_u32 s39, s48, s74
  s_nop 2
  v_mul_f32 v56, v56, v72
  v_mul_f32 v57, v57, v73
  v_mul_f32 v58, v58, v74
  s_waitcnt lgkmcnt(8)
  v_mfma_f32_32x32x16_bf16 v[88:103], v[128:131], v[180:183], v[88:103]
  v_max3_u32 v1, v1, v203, v205
  v_mul_f32 v59, v59, v75
  v_mul_f32 v60, v60, v76
  v_mul_f32 v61, v61, v77
  v_mul_f32 v62, v62, v78
  v_mul_f32 v63, v63, v79
  v_mfma_f32_32x32x16_bf16 v[104:119], v[132:135], v[180:183], v[104:119]
  v_min3_u32 v0, v0, v207, v209
  v_mul_f32 v64, v64, v80
  v_mul_f32 v65, v65, v81
  v_mul_f32 v66, v66, v82
  v_mul_f32 v67, v67, v83
  s_waitcnt lgkmcnt(4)
  v_mfma_f32_32x32x16_bf16 v[88:103], v[136:139], v[184:187], v[88:103]
  v_max3_u32 v1, v1, v207, v209
  v_mul_f32 v68, v68, v84
  v_mul_f32 v69, v69, v85
  v_mul_f32 v70, v70, v86
  v_mul_f32 v71, v71, v87
  v_cvt_pk_bf16_f32 v72, v56, v57
  v_mfma_f32_32x32x16_bf16 v[104:119], v[140:143], v[184:187], v[104:119]
  v_min_u32 v0, v0, v211
  v_cvt_pk_bf16_f32 v73, v58, v59
  v_cvt_pk_bf16_f32 v74, v60, v61
  v_cvt_pk_bf16_f32 v75, v62, v63
  s_waitcnt lgkmcnt(0)
  v_mfma_f32_32x32x16_bf16 v[88:103], v[144:147], v[188:191], v[88:103]
  v_max_u32 v1, v1, v211
  buffer_store_dwordx4 v[72:75], v9, s[96:99], s39 offen offset:0 sc1
  v_cvt_pk_bf16_f32 v76, v64, v65
  v_cvt_pk_bf16_f32 v77, v66, v67
  v_mfma_f32_32x32x16_bf16 v[104:119], v[148:151], v[188:191], v[104:119]
  v_cmp_ne_u32 vcc, s38, v0
  v_cmp_ne_u32_e64 s[100:101], s38, v1
  s_or_b64 vcc, vcc, s[100:101]
  s_cbranch_vccz CSD_12
  s_mov_b32 s43, 4000
CS_11:
  s_lshl1_add_u32 s6, s75, s45
  buffer_load_dwordx4 v[196:199], v9, s[96:99], s6 offen offset:0 sc1
  buffer_load_dwordx4 v[200:203], v9, s[96:99], s6 offen offset:1024 sc1
  buffer_load_dwordx4 v[204:207], v9, s[96:99], s6 offen offset:2048 sc1
  buffer_load_dwordx4 v[208:211], v9, s[96:99], s6 offen offset:3072 sc1
  s_waitcnt vmcnt(0)
  v_min3_u32 v0, v197, v199, v201
  v_max3_u32 v1, v197, v199, v201
  v_min3_u32 v0, v0, v203, v205
  v_max3_u32 v1, v1, v203, v205
  v_min3_u32 v0, v0, v207, v209
  v_max3_u32 v1, v1, v207, v209
  v_min_u32 v0, v0, v211
  v_max_u32 v1, v1, v211
  v_cmp_ne_u32 vcc, s38, v0
  v_cmp_ne_u32_e64 s[100:101], s38, v1
  s_or_b64 vcc, vcc, s[100:101]
  s_cbranch_vccz CSD_12
  s_sub_u32 s43, s43, 1
  s_cmp_lg_u32 s43, 0
  s_cbranch_scc1 CS_11
CSD_12:
  v_mfma_f32_32x32x16_bf16 v[88:103], v[196:199], v[212:215], v[88:103]
  v_cvt_pk_bf16_f32 v78, v68, v69
  v_cvt_pk_bf16_f32 v79, v70, v71
  buffer_store_dwordx4 v[76:79], v9, s[96:99], s39 offen offset:1024 sc1
  v_mfma_f32_32x32x16_bf16 v[104:119], v[204:207], v[212:215], v[104:119]
  v_mfma_f32_32x32x16_bf16 v[88:103], v[200:203], v[212:215], v[88:103]
  v_mfma_f32_32x32x16_bf16 v[104:119], v[208:211], v[212:215], v[104:119]
  s_add_u32 s39, s48, s75
  s_nop 10
  v_mul_f32 v88, v88, v104
  v_mul_f32 v89, v89, v105
  v_mul_f32 v90, v90, v106
  v_mul_f32 v91, v91, v107
  v_mul_f32 v92, v92, v108
  v_mul_f32 v93, v93, v109
  v_mul_f32 v94, v94, v110
  v_mul_f32 v95, v95, v111
  v_mul_f32 v96, v96, v112
  v_mul_f32 v97, v97, v113
  v_mul_f32 v98, v98, v114
  v_mul_f32 v99, v99, v115
  v_mul_f32 v100, v100, v116
  v_mul_f32 v101, v101, v117
  v_mul_f32 v102, v102, v118
  v_mul_f32 v103, v103, v119
  v_cvt_pk_bf16_f32 v104, v88, v89
  v_cvt_pk_bf16_f32 v105, v90, v91
  v_cvt_pk_bf16_f32 v106, v92, v93
  v_cvt_pk_bf16_f32 v107, v94, v95
  buffer_store_dwordx4 v[104:107], v9, s[96:99], s39 offen offset:0 sc1
  v_cvt_pk_bf16_f32 v108, v96, v97
  v_cvt_pk_bf16_f32 v109, v98, v99
  v_cvt_pk_bf16_f32 v110, v100, v101
  v_cvt_pk_bf16_f32 v111, v102, v103
  buffer_store_dwordx4 v[108:111], v9, s[96:99], s39 offen offset:1024 sc1
  s_mul_i32 s50, s36, 240306
  s_add_u32 s51, s50, 218460
  s_lshr_b32 s50, s50, 16
  s_lshr_b32 s51, s51, 16
  v_and_b32 v7, 15, v2
  v_max_u32 v7, s50, v7
  v_min_u32 v7, s51, v7
  v_and_or_b32 v7, v2, 16, v7
  s_lshl_b32 s51, s46, 7
  s_add_u32 s51, s51, 8192
  v_lshl_add_u32 v7, v7, 2, s51
  v_add_u32 v159, 0x10000, v157
  s_barrier
  s_waitcnt vmcnt(14)
  ds_read_b64_tr_b16 v[192:193], v158 offset:0
  ds_read_b64_tr_b16 v[194:195], v158 offset:1024
  ds_read_b64_tr_b16 v[196:197], v159 offset:0
  ds_read_b64_tr_b16 v[198:199], v159 offset:1024
  ds_read_b64_tr_b16 v[200:201], v158 offset:2048
  ds_read_b64_tr_b16 v[202:203], v158 offset:3072
  ds_read_b64_tr_b16 v[204:205], v159 offset:2048
  ds_read_b64_tr_b16 v[206:207], v159 offset:3072
  s_waitcnt vmcnt(10)
  ds_read_b64_tr_b16 v[208:209], v156 offset:16384
  ds_read_b64_tr_b16 v[210:211], v156 offset:17408
  ds_read_b64_tr_b16 v[212:213], v157 offset:16384
  ds_read_b64_tr_b16 v[214:215], v157 offset:17408
  ds_read_b64_tr_b16 v[216:217], v156 offset:18432
  ds_read_b64_tr_b16 v[218:219], v156 offset:19456
  ds_read_b64_tr_b16 v[220:221], v157 offset:18432
  ds_read_b64_tr_b16 v[222:223], v157 offset:19456
  s_add_u32 s50, s14, 0
  s_add_u32 m0, s69, 0
  s_nop 0
  buffer_load_dwordx4 v152, s[56:59], s50 offen offset:0 lds
  buffer_load_dwordx4 v153, s[56:59], s50 offen offset:1024 lds
  buffer_load_dwordx4 v154, s[56:59], s50 offen offset:2048 lds
  buffer_load_dwordx4 v155, s[56:59], s50 offen offset:3072 lds
  s_add_u32 s50, s14, 32768
  s_add_u32 m0, s69, 49152
  s_nop 0
  buffer_load_dwordx4 v152, s[56:59], s50 offen offset:0 lds
  buffer_load_dwordx4 v153, s[56:59], s50 offen offset:1024 lds
  buffer_load_dwordx4 v154, s[56:59], s50 offen offset:2048 lds
  buffer_load_dwordx4 v155, s[56:59], s50 offen offset:3072 lds
  s_waitcnt vmcnt(14)
  ds_read_b64_tr_b16 v[224:225], v156 offset:32768
  ds_read_b64_tr_b16 v[226:227], v156 offset:33792
  ds_read_b64_tr_b16 v[228:229], v157 offset:32768
  ds_read_b64_tr_b16 v[230:231], v157 offset:33792
  ds_read_b64_tr_b16 v[232:233], v156 offset:34816
  ds_read_b64_tr_b16 v[234:235], v156 offset:35840
  ds_read_b64_tr_b16 v[236:237], v157 offset:34816
  ds_read_b64_tr_b16 v[238:239], v157 offset:35840
  s_waitcnt vmcnt(8)
  v_mov_b32 v1, s38
  buffer_store_dword v1, off, s[96:99], s49 sc1
  s_waitcnt lgkmcnt(15)
  s_add_u32 s50, s14, 163840
  s_add_u32 m0, s69, 65536
  s_nop 0
  buffer_load_dwordx4 v152, s[56:59], s50 offen offset:0 lds
  buffer_load_dwordx4 v153, s[56:59], s50 offen offset:1024 lds
  buffer_load_dwordx4 v154, s[56:59], s50 offen offset:2048 lds
  buffer_load_dwordx4 v155, s[56:59], s50 offen offset:3072 lds
  s_waitcnt lgkmcnt(8)
  s_add_u32 s50, s14, 196608
  s_add_u32 m0, s69, 16384
  s_nop 0
  buffer_load_dwordx4 v152, s[56:59], s50 offen offset:0 lds
  buffer_load_dwordx4 v153, s[56:59], s50 offen offset:1024 lds
  buffer_load_dwordx4 v154, s[56:59], s50 offen offset:2048 lds
  buffer_load_dwordx4 v155, s[56:59], s50 offen offset:3072 lds
  s_waitcnt lgkmcnt(0)
  s_add_u32 s50, s14, 229376
  s_add_u32 m0, s69, 32768
  s_nop 0
  buffer_load_dwordx4 v152, s[56:59], s50 offen offset:0 lds
  buffer_load_dwordx4 v153, s[56:59], s50 offen offset:1024 lds
  buffer_load_dwordx4 v154, s[56:59], s50 offen offset:2048 lds
  buffer_load_dwordx4 v155, s[56:59], s50 offen offset:3072 lds
  s_lshr_b32 s43, s36, 1
  s_lshl_b32 s43, s43, 5
  s_lshl_b32 s44, s46, 6
  s_add_u32 s43, s43, s44
  v_and_b32 v14, 31, v2
  v_add_u32 v14, s43, v14
  v_lshlrev_b32 v12, 3, v14
  v_lshrrev_b32 v13, 5, v2
  s_and_b32 s43, s36, 1
  s_lshl_b32 s43, s43, 5
  s_lshl_b32 s44, s47, 6
  s_add_u32 s43, s43, s44
  s_lshl_b32 s44, s43, 1
  v_lshlrev_b32 v15, 10, v14
  v_lshl_add_u32 v15, v13, 4, v15
  v_add_u32 v15, s44, v15
  s_lshl_b32 s43, s43, 12
  v_lshlrev_b32 v14, 2, v14
  v_lshl_add_u32 v14, v13, 15, v14
  v_add_u32 v14, s43, v14
  s_lshr_b32 s43, s46, 3
  s_lshl_b32 s43, s43, 8
  s_lshl_b32 s44, s47, 5
  s_add_u32 s43, s43, s44
  s_lshl_b32 s43, s43, 2
  s_add_u32 s43, s43, 12288
  v_and_b32 v10, 31, v2
  v_lshl_add_u32 v13, v10, 2, s43
  s_add_u32 s72, s34, 3145728
  s_addc_u32 s73, s35, 0
  v_add_u32 v12, 65536, v12
  s_mov_b32 s63, 0xffff0000
  global_load_dwordx4 v[16:19], v15, s[8:9]
  global_load_dwordx4 v[20:23], v15, s[8:9] offset:32
  s_waitcnt vmcnt(10)
  ds_read_b64_tr_b16 v[240:241], v158 offset:0
  ds_read_b64_tr_b16 v[242:243], v158 offset:1024
  ds_read_b64_tr_b16 v[244:245], v159 offset:0
  ds_read_b64_tr_b16 v[246:247], v159 offset:1024
  ds_read_b64_tr_b16 v[248:249], v158 offset:2048
  ds_read_b64_tr_b16 v[250:251], v158 offset:3072
  ds_read_b64_tr_b16 v[252:253], v159 offset:2048
  ds_read_b64_tr_b16 v[254:255], v159 offset:3072
  s_waitcnt lgkmcnt(0)
  s_add_u32 s50, s14, 262144
  s_add_u32 m0, s69, 65536
  s_nop 0
  buffer_load_dwordx4 v152, s[56:59], s50 offen offset:0 lds
  buffer_load_dwordx4 v153, s[56:59], s50 offen offset:1024 lds
  buffer_load_dwordx4 v154, s[56:59], s50 offen offset:2048 lds
  buffer_load_dwordx4 v155, s[56:59], s50 offen offset:3072 lds
  ds_read_b64_tr_b16 v[120:121], v156 offset:0
  ds_read_b64_tr_b16 v[122:123], v156 offset:1024
  ds_read_b64_tr_b16 v[124:125], v157 offset:0
  ds_read_b64_tr_b16 v[126:127], v157 offset:1024
  ds_read_b64_tr_b16 v[128:129], v156 offset:2048
  ds_read_b64_tr_b16 v[130:131], v156 offset:3072
  ds_read_b64_tr_b16 v[132:133], v157 offset:2048
  ds_read_b64_tr_b16 v[134:135], v157 offset:3072
G1JOIN_2:
  s_mov_b32 s43, 4000
FHP_14:
  buffer_load_dword v10, v7, s[96:99], 0 offen sc1
  s_waitcnt vmcnt(0)
  v_cmp_ne_u32 vcc, s38, v10
  s_cbranch_vccz FHD_15
  s_sub_u32 s43, s43, 1
  s_cmp_lg_u32 s43, 0
  s_cbranch_scc1 FHP_14
FHD_15:
  s_add_u32 s54, s52, 0
  s_add_u32 s55, s53, 0
  buffer_load_dwordx4 v[88:91], v9, s[96:99], s54 offen offset:0 sc1
  buffer_load_dwordx4 v[92:95], v9, s[96:99], s55 offen offset:0 sc1
  buffer_load_dwordx4 v[96:99], v9, s[96:99], s54 offen offset:1024 sc1
  buffer_load_dwordx4 v[100:103], v9, s[96:99], s55 offen offset:1024 sc1
  s_add_u32 s54, s52, 2048
  s_add_u32 s55, s53, 2048
  buffer_load_dwordx4 v[104:107], v9, s[96:99], s54 offen offset:0 sc1
  buffer_load_dwordx4 v[108:111], v9, s[96:99], s55 offen offset:0 sc1
  buffer_load_dwordx4 v[112:115], v9, s[96:99], s54 offen offset:1024 sc1
  buffer_load_dwordx4 v[116:119], v9, s[96:99], s55 offen offset:1024 sc1
  s_add_u32 s54, s52, 4096
  s_add_u32 s55, s53, 4096
  buffer_load_dwordx4 v[160:163], v9, s[96:99], s54 offen offset:0 sc1
  buffer_load_dwordx4 v[164:167], v9, s[96:99], s55 offen offset:0 sc1
  buffer_load_dwordx4 v[168:171], v9, s[96:99], s54 offen offset:1024 sc1
  buffer_load_dwordx4 v[172:175], v9, s[96:99], s55 offen offset:1024 sc1
  s_add_u32 s54, s52, 6144
  s_add_u32 s55, s53, 6144
  buffer_load_dwordx4 v[176:179], v9, s[96:99], s54 offen offset:0 sc1
  buffer_load_dwordx4 v[180:183], v9, s[96:99], s55 offen offset:0 sc1
  buffer_load_dwordx4 v[184:187], v9, s[96:99], s54 offen offset:1024 sc1
  buffer_load_dwordx4 v[188:191], v9, s[96:99], s55 offen offset:1024 sc1
  s_waitcnt lgkmcnt(6)
  s_waitcnt vmcnt(12)
  v_mfma_f32_32x32x16_bf16 v[24:39], v[120:123], v[88:91], 0
  ds_read_b64_tr_b16 v[136:137], v156 offset:49152
  ds_read_b64_tr_b16 v[138:139], v156 offset:50176
  s_waitcnt lgkmcnt(6)
  v_mfma_f32_32x32x16_bf16 v[40:55], v[124:127], v[88:91], 0
  ds_read_b64_tr_b16 v[140:141], v157 offset:49152
  ds_read_b64_tr_b16 v[142:143], v157 offset:50176
  v_mfma_f32_32x32x16_bf16 v[56:71], v[120:123], v[92:95], 0
  v_mfma_f32_32x32x16_bf16 v[72:87], v[124:127], v[92:95], 0
  s_setprio 0
  s_waitcnt lgkmcnt(6)
  v_mfma_f32_32x32x16_bf16 v[24:39], v[128:131], v[96:99], v[24:39]
  ds_read_b64_tr_b16 v[144:145], v156 offset:51200
  ds_read_b64_tr_b16 v[146:147], v156 offset:52224
  s_waitcnt lgkmcnt(6)
  v_mfma_f32_32x32x16_bf16 v[40:55], v[132:135], v[96:99], v[40:55]
  ds_read_b64_tr_b16 v[148:149], v157 offset:51200
  ds_read_b64_tr_b16 v[150:151], v157 offset:52224
  v_mfma_f32_32x32x16_bf16 v[56:71], v[128:131], v[100:103], v[56:71]
  s_add_u32 s50, s14, 294912
  v_mfma_f32_32x32x16_bf16 v[72:87], v[132:135], v[100:103], v[72:87]
  s_add_u32 m0, s69, 0
  s_add_u32 s54, s52, 8192
  s_waitcnt lgkmcnt(6)
  s_waitcnt vmcnt(8)
  v_mfma_f32_32x32x16_bf16 v[24:39], v[136:139], v[104:107], v[24:39]
  buffer_load_dwordx4 v152, s[56:59], s50 offen offset:0 lds
  s_add_u32 s55, s53, 8192
  s_waitcnt lgkmcnt(4)
  v_mfma_f32_32x32x16_bf16 v[40:55], v[140:143], v[104:107], v[40:55]
  buffer_load_dwordx4 v153, s[56:59], s50 offen offset:1024 lds
  buffer_load_dwordx4 v[88:91], v9, s[96:99], s54 offen offset:0 sc1
  v_mfma_f32_32x32x16_bf16 v[56:71], v[136:139], v[108:111], v[56:71]
  buffer_load_dwordx4 v154, s[56:59], s50 offen offset:2048 lds
  buffer_load_dwordx4 v[92:95], v9, s[96:99], s55 offen offset:0 sc1
  v_mfma_f32_32x32x16_bf16 v[72:87], v[140:143], v[108:111], v[72:87]
  buffer_load_dwordx4 v155, s[56:59], s50 offen offset:3072 lds
  buffer_load_dwordx4 v[96:99], v9, s[96:99], s54 offen offset:1024 sc1
  s_waitcnt lgkmcnt(2)
  v_mfma_f32_32x32x16_bf16 v[24:39], v[144:147], v[112:115], v[24:39]
  buffer_load_dwordx4 v[100:103], v9, s[96:99], s55 offen offset:1024 sc1
  s_waitcnt lgkmcnt(0)
  v_mfma_f32_32x32x16_bf16 v[40:55], v[148:151], v[112:115], v[40:55]
  v_mfma_f32_32x32x16_bf16 v[56:71], v[144:147], v[116:119], v[56:71]
  s_add_u32 s50, s14, 327680
  v_mfma_f32_32x32x16_bf16 v[72:87], v[148:151], v[116:119], v[72:87]
  s_add_u32 m0, s69, 49152
  s_add_u32 s54, s52, 10240
  s_waitcnt vmcnt(12)
  v_mfma_f32_32x32x16_bf16 v[24:39], v[192:195], v[160:163], v[24:39]
  buffer_load_dwordx4 v152, s[56:59], s50 offen offset:0 lds
  s_add_u32 s55, s53, 10240
  v_mfma_f32_32x32x16_bf16 v[40:55], v[196:199], v[160:163], v[40:55]
  buffer_load_dwordx4 v153, s[56:59], s50 offen offset:1024 lds
  buffer_load_dwordx4 v[104:107], v9, s[96:99], s54 offen offset:0 sc1
  v_mfma_f32_32x32x16_bf16 v[56:71], v[192:195], v[164:167], v[56:71]
  buffer_load_dwordx4 v154, s[56:59], s50 offen offset:2048 lds
  buffer_load_dwordx4 v[108:111], v9, s[96:99], s55 offen offset:0 sc1
  v_mfma_f32_32x32x16_bf16 v[72:87], v[196:199], v[164:167], v[72:87]
  buffer_load_dwordx4 v155, s[56:59], s50 offen offset:3072 lds
  buffer_load_dwordx4 v[112:115], v9, s[96:99], s54 offen offset:1024 sc1
  v_mfma_f32_32x32x16_bf16 v[24:39], v[200:203], v[168:171], v[24:39]
  buffer_load_dwordx4 v[116:119], v9, s[96:99], s55 offen offset:1024 sc1
  v_mfma_f32_32x32x16_bf16 v[40:55], v[204:207], v[168:171], v[40:55]
  v_mfma_f32_32x32x16_bf16 v[56:71], v[200:203], v[172:175], v[56:71]
  v_mfma_f32_32x32x16_bf16 v[72:87], v[204:207], v[172:175], v[72:87]
  s_add_u32 s54, s52, 12288
  s_waitcnt vmcnt(16)
  v_mfma_f32_32x32x16_bf16 v[24:39], v[208:211], v[176:179], v[24:39]
  s_add_u32 s55, s53, 12288
  v_mfma_f32_32x32x16_bf16 v[40:55], v[212:215], v[176:179], v[40:55]
  buffer_load_dwordx4 v[192:195], v9, s[96:99], s54 offen offset:0 sc1
  v_mfma_f32_32x32x16_bf16 v[56:71], v[208:211], v[180:183], v[56:71]
  buffer_load_dwordx4 v[196:199], v9, s[96:99], s55 offen offset:0 sc1
  v_mfma_f32_32x32x16_bf16 v[72:87], v[212:215], v[180:183], v[72:87]
  buffer_load_dwordx4 v[200:203], v9, s[96:99], s54 offen offset:1024 sc1
  s_add_u32 s54, s52, 14336
  v_mfma_f32_32x32x16_bf16 v[24:39], v[216:219], v[184:187], v[24:39]
  buffer_load_dwordx4 v[204:207], v9, s[96:99], s55 offen offset:1024 sc1
  s_add_u32 s55, s53, 14336
  v_mfma_f32_32x32x16_bf16 v[40:55], v[220:223], v[184:187], v[40:55]
  buffer_load_dwordx4 v[160:163], v9, s[96:99], s54 offen offset:0 sc1
  v_mfma_f32_32x32x16_bf16 v[56:71], v[216:219], v[188:191], v[56:71]
  buffer_load_dwordx4 v[164:167], v9, s[96:99], s55 offen offset:0 sc1
  v_mfma_f32_32x32x16_bf16 v[72:87], v[220:223], v[188:191], v[72:87]
  buffer_load_dwordx4 v[168:171], v9, s[96:99], s54 offen offset:1024 sc1
  s_add_u32 s54, s52, 16384
  s_waitcnt vmcnt(15)
  v_mfma_f32_32x32x16_bf16 v[24:39], v[224:227], v[88:91], v[24:39]
  buffer_load_dwordx4 v[172:175], v9, s[96:99], s55 offen offset:1024 sc1
  s_add_u32 s55, s53, 16384
  v_mfma_f32_32x32x16_bf16 v[40:55], v[228:231], v[88:91], v[40:55]
  buffer_load_dwordx4 v[208:211], v9, s[96:99], s54 offen offset:0 sc1
  v_mfma_f32_32x32x16_bf16 v[56:71], v[224:227], v[92:95], v[56:71]
  buffer_load_dwordx4 v[212:215], v9, s[96:99], s55 offen offset:0 sc1
  v_mfma_f32_32x32x16_bf16 v[72:87], v[228:231], v[92:95], v[72:87]
  buffer_load_dwordx4 v[216:219], v9, s[96:99], s54 offen offset:1024 sc1
  s_add_u32 s54, s52, 18432
  v_mfma_f32_32x32x16_bf16 v[24:39], v[232:235], v[96:99], v[24:39]
  buffer_load_dwordx4 v[220:223], v9, s[96:99], s55 offen offset:1024 sc1
  s_add_u32 s55, s53, 18432
  v_mfma_f32_32x32x16_bf16 v[40:55], v[236:239], v[96:99], v[40:55]
  buffer_load_dwordx4 v[176:179], v9, s[96:99], s54 offen offset:0 sc1
  v_mfma_f32_32x32x16_bf16 v[56:71], v[232:235], v[100:103], v[56:71]
  buffer_load_dwordx4 v[180:183], v9, s[96:99], s55 offen offset:0 sc1
  v_mfma_f32_32x32x16_bf16 v[72:87], v[236:239], v[100:103], v[72:87]
  buffer_load_dwordx4 v[184:187], v9, s[96:99], s54 offen offset:1024 sc1
  s_add_u32 s54, s52, 20480
  s_waitcnt vmcnt(15)
  v_mfma_f32_32x32x16_bf16 v[24:39], v[240:243], v[104:107], v[24:39]
  ds_read_b64_tr_b16 v[120:121], v156 offset:16384
  ds_read_b64_tr_b16 v[122:123], v156 offset:17408
  buffer_load_dwordx4 v[188:191], v9, s[96:99], s55 offen offset:1024 sc1
  s_add_u32 s55, s53, 20480
  v_mfma_f32_32x32x16_bf16 v[40:55], v[244:247], v[104:107], v[40:55]
  ds_read_b64_tr_b16 v[124:125], v157 offset:16384
  ds_read_b64_tr_b16 v[126:127], v157 offset:17408
  buffer_load_dwordx4 v[224:227], v9, s[96:99], s54 offen offset:0 sc1
  v_mfma_f32_32x32x16_bf16 v[56:71], v[240:243], v[108:111], v[56:71]
  buffer_load_dwordx4 v[228:231], v9, s[96:99], s55 offen offset:0 sc1
  v_mfma_f32_32x32x16_bf16 v[72:87], v[244:247], v[108:111], v[72:87]
  buffer_load_dwordx4 v[232:235], v9, s[96:99], s54 offen offset:1024 sc1
  v_mfma_f32_32x32x16_bf16 v[24:39], v[248:251], v[112:115], v[24:39]
  ds_read_b64_tr_b16 v[128:129], v156 offset:18432
  ds_read_b64_tr_b16 v[130:131], v156 offset:19456
  buffer_load_dwordx4 v[236:239], v9, s[96:99], s55 offen offset:1024 sc1
  v_mfma_f32_32x32x16_bf16 v[40:55], v[252:255], v[112:115], v[40:55]
  ds_read_b64_tr_b16 v[132:133], v157 offset:18432
  ds_read_b64_tr_b16 v[134:135], v157 offset:19456
  v_mfma_f32_32x32x16_bf16 v[56:71], v[248:251], v[116:119], v[56:71]
  v_mfma_f32_32x32x16_bf16 v[72:87], v[252:255], v[116:119], v[72:87]
  s_waitcnt lgkmcnt(6)
  s_waitcnt vmcnt(16)
  v_mfma_f32_32x32x16_bf16 v[24:39], v[120:123], v[192:195], v[24:39]
  ds_read_b64_tr_b16 v[136:137], v156 offset:32768
  ds_read_b64_tr_b16 v[138:139], v156 offset:33792
  s_waitcnt lgkmcnt(6)
  v_mfma_f32_32x32x16_bf16 v[40:55], v[124:127], v[192:195], v[40:55]
  ds_read_b64_tr_b16 v[140:141], v157 offset:32768
  ds_read_b64_tr_b16 v[142:143], v157 offset:33792
  v_mfma_f32_32x32x16_bf16 v[56:71], v[120:123], v[196:199], v[56:71]
  v_mfma_f32_32x32x16_bf16 v[72:87], v[124:127], v[196:199], v[72:87]
  s_waitcnt lgkmcnt(6)
  v_mfma_f32_32x32x16_bf16 v[24:39], v[128:131], v[200:203], v[24:39]
  ds_read_b64_tr_b16 v[144:145], v156 offset:34816
  ds_read_b64_tr_b16 v[146:147], v156 offset:35840
  s_waitcnt lgkmcnt(6)
  v_mfma_f32_32x32x16_bf16 v[40:55], v[132:135], v[200:203], v[40:55]
  ds_read_b64_tr_b16 v[148:149], v157 offset:34816
  ds_read_b64_tr_b16 v[150:151], v157 offset:35840
  v_mfma_f32_32x32x16_bf16 v[56:71], v[128:131], v[204:207], v[56:71]
  v_mfma_f32_32x32x16_bf16 v[72:87], v[132:135], v[204:207], v[72:87]
  s_waitcnt lgkmcnt(6)
  s_waitcnt vmcnt(12)
  v_mfma_f32_32x32x16_bf16 v[24:39], v[136:139], v[160:163], v[24:39]
  ds_read_b64_tr_b16 v[120:121], v158 offset:0
  ds_read_b64_tr_b16 v[122:123], v158 offset:1024
  s_waitcnt lgkmcnt(6)
  v_mfma_f32_32x32x16_bf16 v[40:55], v[140:143], v[160:163], v[40:55]
  ds_read_b64_tr_b16 v[124:125], v159 offset:0
  ds_read_b64_tr_b16 v[126:127], v159 offset:1024
  v_mfma_f32_32x32x16_bf16 v[56:71], v[136:139], v[164:167], v[56:71]
  buffer_load_dword v12, v12, s[96:99], 0 offen sc1
  v_mfma_f32_32x32x16_bf16 v[72:87], v[140:143], v[164:167], v[72:87]
  s_waitcnt lgkmcnt(6)
  v_mfma_f32_32x32x16_bf16 v[24:39], v[144:147], v[168:171], v[24:39]
  ds_read_b64_tr_b16 v[128:129], v158 offset:2048
  ds_read_b64_tr_b16 v[130:131], v158 offset:3072
  s_waitcnt lgkmcnt(6)
  v_mfma_f32_32x32x16_bf16 v[40:55], v[148:151], v[168:171], v[40:55]
  ds_read_b64_tr_b16 v[132:133], v159 offset:2048
  ds_read_b64_tr_b16 v[134:135], v159 offset:3072
  v_mfma_f32_32x32x16_bf16 v[56:71], v[144:147], v[172:175], v[56:71]
  v_mfma_f32_32x32x16_bf16 v[72:87], v[148:151], v[172:175], v[72:87]
  s_waitcnt lgkmcnt(6)
  s_waitcnt vmcnt(9)
  v_mfma_f32_32x32x16_bf16 v[24:39], v[120:123], v[208:211], v[24:39]
  ds_read_b64_tr_b16 v[136:137], v156 offset:0
  ds_read_b64_tr_b16 v[138:139], v156 offset:1024
  s_waitcnt lgkmcnt(6)
  v_mfma_f32_32x32x16_bf16 v[40:55], v[124:127], v[208:211], v[40:55]
  ds_read_b64_tr_b16 v[140:141], v157 offset:0
  ds_read_b64_tr_b16 v[142:143], v157 offset:1024
  v_mfma_f32_32x32x16_bf16 v[56:71], v[120:123], v[212:215], v[56:71]
  global_load_dword v11, v13, s[34:35] sc1
  v_mfma_f32_32x32x16_bf16 v[72:87], v[124:127], v[212:215], v[72:87]
  s_waitcnt lgkmcnt(6)
  v_mfma_f32_32x32x16_bf16 v[24:39], v[128:131], v[216:219], v[24:39]
  ds_read_b64_tr_b16 v[144:145], v156 offset:2048
  ds_read_b64_tr_b16 v[146:147], v156 offset:3072
  s_waitcnt lgkmcnt(6)
  v_mfma_f32_32x32x16_bf16 v[40:55], v[132:135], v[216:219], v[40:55]
  ds_read_b64_tr_b16 v[148:149], v157 offset:2048
  ds_read_b64_tr_b16 v[150:151], v157 offset:3072
  v_mfma_f32_32x32x16_bf16 v[56:71], v[128:131], v[220:223], v[56:71]
  v_mfma_f32_32x32x16_bf16 v[72:87], v[132:135], v[220:223], v[72:87]
  s_waitcnt lgkmcnt(6)
  s_waitcnt vmcnt(6)
  v_mfma_f32_32x32x16_bf16 v[24:39], v[136:139], v[176:179], v[24:39]
  ds_read_b64_tr_b16 v[120:121], v156 offset:49152
  ds_read_b64_tr_b16 v[122:123], v156 offset:50176
  s_waitcnt lgkmcnt(6)
  v_mfma_f32_32x32x16_bf16 v[40:55], v[140:143], v[176:179], v[40:55]
  ds_read_b64_tr_b16 v[124:125], v157 offset:49152
  ds_read_b64_tr_b16 v[126:127], v157 offset:50176
  v_mfma_f32_32x32x16_bf16 v[56:71], v[136:139], v[180:183], v[56:71]
  v_mfma_f32_32x32x16_bf16 v[72:87], v[140:143], v[180:183], v[72:87]
  s_waitcnt lgkmcnt(6)
  v_mfma_f32_32x32x16_bf16 v[24:39], v[144:147], v[184:187], v[24:39]
  ds_read_b64_tr_b16 v[128:129], v156 offset:51200
  ds_read_b64_tr_b16 v[130:131], v156 offset:52224
  s_waitcnt vmcnt(0)
  v_cmp_ne_u32 vcc, s38, v11
  s_cmp_eq_u64 vcc, 0
  s_cselect_b32 s51, 1, 0
  s_waitcnt lgkmcnt(6)
  v_mfma_f32_32x32x16_bf16 v[40:55], v[148:151], v[184:187], v[40:55]
  ds_read_b64_tr_b16 v[132:133], v157 offset:51200
  ds_read_b64_tr_b16 v[134:135], v157 offset:52224
  v_mov_b32 v10, v14
  global_load_dword v240, v10, s[72:73] sc1
  v_add_u32 v10, 8192, v14
  global_load_dword v241, v10, s[72:73] sc1
  v_add_u32 v10, 16384, v14
  global_load_dword v242, v10, s[72:73] sc1
  v_mfma_f32_32x32x16_bf16 v[56:71], v[144:147], v[188:191], v[56:71]
  v_add_u32 v10, 24576, v14
  global_load_dword v243, v10, s[72:73] sc1
  v_add_u32 v10, 65536, v14
  global_load_dword v244, v10, s[72:73] sc1
  v_add_u32 v10, 73728, v14
  v_mfma_f32_32x32x16_bf16 v[72:87], v[148:151], v[188:191], v[72:87]
  global_load_dword v245, v10, s[72:73] sc1
  v_add_u32 v10, 81920, v14
  global_load_dword v246, v10, s[72:73] sc1
  v_add_u32 v10, 90112, v14
  global_load_dword v247, v10, s[72:73] sc1
  s_waitcnt lgkmcnt(6)
  s_cmp_eq_u32 s36, 3
  s_cbranch_scc1 NOU10
  v_mfma_f32_32x32x16_bf16 v[24:39], v[120:123], v[224:227], v[24:39]
  s_waitcnt lgkmcnt(4)
  v_mfma_f32_32x32x16_bf16 v[40:55], v[124:127], v[224:227], v[40:55]
  v_mfma_f32_32x32x16_bf16 v[56:71], v[120:123], v[228:231], v[56:71]
  v_mfma_f32_32x32x16_bf16 v[72:87], v[124:127], v[228:231], v[72:87]
  s_waitcnt lgkmcnt(2)
  v_mfma_f32_32x32x16_bf16 v[24:39], v[128:131], v[232:235], v[24:39]
  s_waitcnt lgkmcnt(0)
  v_mfma_f32_32x32x16_bf16 v[40:55], v[132:135], v[232:235], v[40:55]
  v_mfma_f32_32x32x16_bf16 v[56:71], v[128:131], v[236:239], v[56:71]
  v_mfma_f32_32x32x16_bf16 v[72:87], v[132:135], v[236:239], v[72:87]
NOU10:
  s_setprio 1
  s_cmp_eq_u32 s51, 1
  s_cbranch_scc1 AL0_16
  global_load_dword v11, v13, s[34:35] sc1
AL0_16:
  v_add_u32 v3, s69, v9
  s_xor_b32 s44, s36, 1
  s_lshl_b32 s44, s44, 12
  v_add_u32 v4, s44, v9
  s_xor_b32 s44, s36, 2
  s_lshl_b32 s44, s44, 12
  s_add_u32 s44, s44, 16384
  v_add_u32 v5, s44, v9
  s_xor_b32 s44, s36, 3
  s_lshl_b32 s44, s44, 12
  s_add_u32 s44, s44, 32768
  v_add_u32 v6, s44, v9
  v_and_b32 v1, s63, v12
  v_rcp_f32 v1, v1
  s_waitcnt lgkmcnt(0)
  ds_write_b128 v3, v[40:43] offset:0
  ds_write_b128 v3, v[44:47] offset:1024
  ds_write_b128 v3, v[48:51] offset:2048
  ds_write_b128 v3, v[52:55] offset:3072
  ds_write_b128 v3, v[56:59] offset:16384
  ds_write_b128 v3, v[60:63] offset:17408
  ds_write_b128 v3, v[64:67] offset:18432
  ds_write_b128 v3, v[68:71] offset:19456
  ds_write_b128 v3, v[72:75] offset:32768
  ds_write_b128 v3, v[76:79] offset:33792
  ds_write_b128 v3, v[80:83] offset:34816
  ds_write_b128 v3, v[84:87] offset:35840
  v_mul_f32 v1, v1, v1
  s_waitcnt lgkmcnt(0)
  s_barrier
  ds_read_b128 v[96:99], v4 offset:0
  ds_read_b128 v[100:103], v4 offset:1024
  ds_read_b128 v[104:107], v4 offset:2048
  ds_read_b128 v[108:111], v4 offset:3072
  ds_read_b128 v[112:115], v5 offset:0
  ds_read_b128 v[116:119], v5 offset:1024
  ds_read_b128 v[120:123], v5 offset:2048
  ds_read_b128 v[124:127], v5 offset:3072
  ds_read_b128 v[128:131], v6 offset:0
  ds_read_b128 v[132:135], v6 offset:1024
  ds_read_b128 v[136:139], v6 offset:2048
  ds_read_b128 v[140:143], v6 offset:3072
  s_waitcnt lgkmcnt(8)
  v_add_f32 v24, v24, v96
  v_add_f32 v25, v25, v97
  v_add_f32 v26, v26, v98
  v_add_f32 v27, v27, v99
  v_add_f32 v28, v28, v100
  v_add_f32 v29, v29, v101
  v_add_f32 v30, v30, v102
  v_add_f32 v31, v31, v103
  v_add_f32 v32, v32, v104
  v_add_f32 v33, v33, v105
  v_add_f32 v34, v34, v106
  v_add_f32 v35, v35, v107
  v_add_f32 v36, v36, v108
  v_add_f32 v37, v37, v109
  v_add_f32 v38, v38, v110
  v_add_f32 v39, v39, v111
  s_waitcnt lgkmcnt(4)
  v_add_f32 v24, v24, v112
  v_add_f32 v25, v25, v113
  v_add_f32 v26, v26, v114
  v_add_f32 v27, v27, v115
  v_add_f32 v28, v28, v116
  v_add_f32 v29, v29, v117
  v_add_f32 v30, v30, v118
  v_add_f32 v31, v31, v119
  v_add_f32 v32, v32, v120
  v_add_f32 v33, v33, v121
  v_add_f32 v34, v34, v122
  v_add_f32 v35, v35, v123
  v_add_f32 v36, v36, v124
  v_add_f32 v37, v37, v125
  v_add_f32 v38, v38, v126
  v_add_f32 v39, v39, v127
  s_waitcnt lgkmcnt(0)
  v_add_f32 v24, v24, v128
  v_add_f32 v25, v25, v129
  v_add_f32 v26, v26, v130
  v_add_f32 v27, v27, v131
  v_add_f32 v28, v28, v132
  v_add_f32 v29, v29, v133
  v_add_f32 v30, v30, v134
  v_add_f32 v31, v31, v135
  v_add_f32 v32, v32, v136
  v_add_f32 v33, v33, v137
  v_add_f32 v34, v34, v138
  v_add_f32 v35, v35, v139
  v_add_f32 v36, v36, v140
  v_add_f32 v37, v37, v141
  v_add_f32 v38, v38, v142
  v_add_f32 v39, v39, v143
  v_mul_f32 v24, v24, v1
  v_mul_f32 v25, v25, v1
  v_mul_f32 v26, v26, v1
  v_mul_f32 v27, v27, v1
  v_mul_f32 v28, v28, v1
  v_mul_f32 v29, v29, v1
  v_mul_f32 v30, v30, v1
  v_mul_f32 v31, v31, v1
  v_mul_f32 v32, v32, v1
  v_mul_f32 v33, v33, v1
  v_mul_f32 v34, v34, v1
  v_mul_f32 v35, v35, v1
  v_mul_f32 v36, v36, v1
  v_mul_f32 v37, v37, v1
  v_mul_f32 v38, v38, v1
  v_mul_f32 v39, v39, v1
  v_cvt_pk_bf16_f32 v112, v24, v25
  v_cvt_pk_bf16_f32 v113, v26, v27
  v_cvt_pk_bf16_f32 v114, v28, v29
  v_cvt_pk_bf16_f32 v115, v30, v31
  v_cvt_pk_bf16_f32 v116, v32, v33
  v_cvt_pk_bf16_f32 v117, v34, v35
  v_cvt_pk_bf16_f32 v118, v36, v37
  v_cvt_pk_bf16_f32 v119, v38, v39
  v_permlane32_swap_b32 v112, v114
  v_permlane32_swap_b32 v113, v115
  v_permlane32_swap_b32 v116, v118
  v_permlane32_swap_b32 v117, v119
  s_cmp_eq_u32 s51, 1
  s_cbranch_scc1 AOK_17
  s_waitcnt vmcnt(0)
  v_cmp_ne_u32 vcc, s38, v11
  s_cbranch_vccz AGOT_18
  s_mov_b32 s43, 4000
POLL_19:
  global_load_dword v11, v13, s[34:35] sc1
  s_waitcnt vmcnt(0)
  v_cmp_ne_u32 vcc, s38, v11
  s_cbranch_vccz POLLD_20
  s_sub_u32 s43, s43, 1
  s_cmp_lg_u32 s43, 0
  s_cbranch_scc1 POLL_19
POLLD_20:
AGOT_18:
  v_mov_b32 v10, v14
  global_load_dword v240, v10, s[72:73] sc1
  v_add_u32 v10, 8192, v14
  global_load_dword v241, v10, s[72:73] sc1
  v_add_u32 v10, 16384, v14
  global_load_dword v242, v10, s[72:73] sc1
  v_add_u32 v10, 24576, v14
  global_load_dword v243, v10, s[72:73] sc1
  v_add_u32 v10, 65536, v14
  global_load_dword v244, v10, s[72:73] sc1
  v_add_u32 v10, 73728, v14
  global_load_dword v245, v10, s[72:73] sc1
  v_add_u32 v10, 81920, v14
  global_load_dword v246, v10, s[72:73] sc1
  v_add_u32 v10, 90112, v14
  global_load_dword v247, v10, s[72:73] sc1
AOK_17:
  s_waitcnt vmcnt(0)
  v_lshlrev_b32 v8, 16, v16
  v_and_b32 v9, s63, v16
  v_lshlrev_b32 v10, 16, v240
  v_and_b32 v11, s63, v240
  v_add_f32 v8, v8, v10
  v_add_f32 v9, v9, v11
  v_cvt_pk_bf16_f32 v16, v8, v9
  v_lshlrev_b32 v8, 16, v17
  v_and_b32 v9, s63, v17
  v_lshlrev_b32 v10, 16, v241
  v_and_b32 v11, s63, v241
  v_add_f32 v8, v8, v10
  v_add_f32 v9, v9, v11
  v_cvt_pk_bf16_f32 v17, v8, v9
  v_lshlrev_b32 v8, 16, v18
  v_and_b32 v9, s63, v18
  v_lshlrev_b32 v10, 16, v242
  v_and_b32 v11, s63, v242
  v_add_f32 v8, v8, v10
  v_add_f32 v9, v9, v11
  v_cvt_pk_bf16_f32 v18, v8, v9
  v_lshlrev_b32 v8, 16, v19
  v_and_b32 v9, s63, v19
  v_lshlrev_b32 v10, 16, v243
  v_and_b32 v11, s63, v243
  v_add_f32 v8, v8, v10
  v_add_f32 v9, v9, v11
  v_cvt_pk_bf16_f32 v19, v8, v9
  v_lshlrev_b32 v8, 16, v20
  v_and_b32 v9, s63, v20
  v_lshlrev_b32 v10, 16, v244
  v_and_b32 v11, s63, v244
  v_add_f32 v8, v8, v10
  v_add_f32 v9, v9, v11
  v_cvt_pk_bf16_f32 v20, v8, v9
  v_lshlrev_b32 v8, 16, v21
  v_and_b32 v9, s63, v21
  v_lshlrev_b32 v10, 16, v245
  v_and_b32 v11, s63, v245
  v_add_f32 v8, v8, v10
  v_add_f32 v9, v9, v11
  v_cvt_pk_bf16_f32 v21, v8, v9
  v_lshlrev_b32 v8, 16, v22
  v_and_b32 v9, s63, v22
  v_lshlrev_b32 v10, 16, v246
  v_and_b32 v11, s63, v246
  v_add_f32 v8, v8, v10
  v_add_f32 v9, v9, v11
  v_cvt_pk_bf16_f32 v22, v8, v9
  v_lshlrev_b32 v8, 16, v23
  v_and_b32 v9, s63, v23
  v_lshlrev_b32 v10, 16, v247
  v_and_b32 v11, s63, v247
  v_add_f32 v8, v8, v10
  v_add_f32 v9, v9, v11
  v_cvt_pk_bf16_f32 v23, v8, v9
  v_lshlrev_b32 v8, 16, v112
  v_and_b32 v9, s63, v112
  v_lshlrev_b32 v10, 16, v16
  v_and_b32 v11, s63, v16
  v_add_f32 v8, v8, v10
  v_add_f32 v9, v9, v11
  v_cvt_pk_bf16_f32 v120, v8, v9
  v_lshlrev_b32 v8, 16, v113
  v_and_b32 v9, s63, v113
  v_lshlrev_b32 v10, 16, v17
  v_and_b32 v11, s63, v17
  v_add_f32 v8, v8, v10
  v_add_f32 v9, v9, v11
  v_cvt_pk_bf16_f32 v121, v8, v9
  v_lshlrev_b32 v8, 16, v114
  v_and_b32 v9, s63, v114
  v_lshlrev_b32 v10, 16, v18
  v_and_b32 v11, s63, v18
  v_add_f32 v8, v8, v10
  v_add_f32 v9, v9, v11
  v_cvt_pk_bf16_f32 v122, v8, v9
  v_lshlrev_b32 v8, 16, v115
  v_and_b32 v9, s63, v115
  v_lshlrev_b32 v10, 16, v19
  v_and_b32 v11, s63, v19
  v_add_f32 v8, v8, v10
  v_add_f32 v9, v9, v11
  v_cvt_pk_bf16_f32 v123, v8, v9
  global_store_dwordx4 v15, v[120:123], s[30:31]
  v_lshlrev_b32 v8, 16, v116
  v_and_b32 v9, s63, v116
  v_lshlrev_b32 v10, 16, v20
  v_and_b32 v11, s63, v20
  v_add_f32 v8, v8, v10
  v_add_f32 v9, v9, v11
  v_cvt_pk_bf16_f32 v124, v8, v9
  v_lshlrev_b32 v8, 16, v117
  v_and_b32 v9, s63, v117
  v_lshlrev_b32 v10, 16, v21
  v_and_b32 v11, s63, v21
  v_add_f32 v8, v8, v10
  v_add_f32 v9, v9, v11
  v_cvt_pk_bf16_f32 v125, v8, v9
  v_lshlrev_b32 v8, 16, v118
  v_and_b32 v9, s63, v118
  v_lshlrev_b32 v10, 16, v22
  v_and_b32 v11, s63, v22
  v_add_f32 v8, v8, v10
  v_add_f32 v9, v9, v11
  v_cvt_pk_bf16_f32 v126, v8, v9
  v_lshlrev_b32 v8, 16, v119
  v_and_b32 v9, s63, v119
  v_lshlrev_b32 v10, 16, v23
  v_and_b32 v11, s63, v23
  v_add_f32 v8, v8, v10
  v_add_f32 v9, v9, v11
  v_cvt_pk_bf16_f32 v127, v8, v9
  global_store_dwordx4 v15, v[124:127], s[30:31] offset:32
  s_endpgm
G1SKIP_1:
  v_mov_b32 v0, 0
  global_load_dword v0, v0, s[34:35] sc1
  v_lshrrev_b32 v20, 5, v2
  v_bfe_u32 v21, v2, 2, 2
  v_lshl_add_u32 v20, v20, 3, v21
  v_mul_u32_u24 v20, 192, v20
  v_bfe_u32 v21, v2, 4, 1
  v_lshl_add_u32 v20, v21, 5, v20
  v_and_b32 v21, 3, v2
  v_lshl_add_u32 v8, v21, 3, v20
  v_add_u32 v7, 0x8000, v8
  v_lshlrev_b32 v9, 4, v2
  s_and_b32 s46, s37, 7
  s_lshl_b32 s46, s46, 2
  s_lshr_b32 s47, s37, 6
  s_add_u32 s46, s46, s47
  s_lshr_b32 s47, s37, 3
  s_and_b32 s47, s47, 7
  s_mul_i32 s14, s36, 360448
  s_lshl_b32 s69, s36, 12
  s_lshl_b32 s43, s40, 2
  s_add_u32 s43, s43, s36
  s_mul_i32 s44, s43, 88064
  s_lshl_b32 s45, s42, 6
  s_add_u32 s44, s44, s45
  s_add_u32 s48, s44, 5242880
  s_lshl_b32 s43, s43, 6
  s_lshl_b32 s44, s41, 2
  s_add_u32 s43, s43, s44
  s_add_u32 s49, s43, 8192
  s_lshr_b32 s43, s36, 1
  s_lshl_b32 s44, s46, 1
  s_add_u32 s45, s44, s43
  s_xor_b32 s43, s43, 1
  s_add_u32 s44, s44, s43
  s_mul_i32 s45, s45, 88064
  s_mul_i32 s44, s44, 88064
  s_mul_i32 s43, s36, 22528
  s_add_u32 s43, s43, 5242880
  s_add_u32 s52, s45, s43
  s_add_u32 s53, s44, s43
  s_lshl_b32 s43, s40, 7
  s_lshl_b32 s44, s36, 5
  s_add_u32 s43, s43, s44
  s_lshl_b32 s43, s43, 3
  s_add_u32 s44, s43, 65536
  s_lshl_b32 s45, s42, 4
  s_add_u32 s45, s45, 131072
  v_lshrrev_b32 v152, 3, v2
  v_lshlrev_b32 v152, 10, v152
  v_bfe_u32 v153, v2, 4, 1
  v_lshlrev_b32 v153, 2, v153
  v_and_b32 v154, 7, v2
  v_xor_b32 v153, v153, v154
  v_lshl_add_u32 v152, v153, 4, v152
  s_lshl_b32 s51, s47, 7
  v_add_u32 v152, s51, v152
  v_add_u32 v153, 7168, v152
  v_add_u32 v154, 14336, v152
  v_add_u32 v155, 21504, v152
  v_lshrrev_b32 v156, 5, v2
  v_bfe_u32 v157, v2, 2, 2
  v_lshl_add_u32 v156, v156, 2, v157
  v_lshlrev_b32 v156, 7, v156
  v_lshrrev_b32 v157, 1, v157
  v_lshl_add_u32 v156, v157, 6, v156
  v_bfe_u32 v157, v2, 4, 1
  v_lshl_add_u32 v156, v157, 5, v156
  v_and_b32 v157, 3, v2
  v_lshl_add_u32 v156, v157, 3, v156
  s_and_b32 s51, s36, 1
  s_lshl_b32 s51, s51, 6
  v_xor_b32 v156, s51, v156
  v_add_u32 v156, s69, v156
  v_xor_b32 v157, 64, v156
  v_add_u32 v158, 0x10000, v156
  s_waitcnt vmcnt(0)
  v_readfirstlane_b32 s38, v0
  s_mul_i32 s38, s38, 0x9E3779B1
  s_add_u32 s38, s38, 0x7F4A7C15
  s_and_b32 s38, s38, 0xBFFFBFFF
  s_add_u32 s50, s14, 65536
  s_add_u32 m0, s69, 65536
  s_nop 0
  buffer_load_dwordx4 v152, s[56:59], s50 offen offset:0 lds
  buffer_load_dwordx4 v153, s[56:59], s50 offen offset:1024 lds
  buffer_load_dwordx4 v154, s[56:59], s50 offen offset:2048 lds
  buffer_load_dwordx4 v155, s[56:59], s50 offen offset:3072 lds
  s_add_u32 s50, s14, 98304
  s_add_u32 m0, s69, 16384
  s_nop 0
  buffer_load_dwordx4 v152, s[56:59], s50 offen offset:0 lds
  buffer_load_dwordx4 v153, s[56:59], s50 offen offset:1024 lds
  buffer_load_dwordx4 v154, s[56:59], s50 offen offset:2048 lds
  buffer_load_dwordx4 v155, s[56:59], s50 offen offset:3072 lds
  s_add_u32 s50, s14, 131072
  s_add_u32 m0, s69, 32768
  s_nop 0
  buffer_load_dwordx4 v152, s[56:59], s50 offen offset:0 lds
  buffer_load_dwordx4 v153, s[56:59], s50 offen offset:1024 lds
  buffer_load_dwordx4 v154, s[56:59], s50 offen offset:2048 lds
  buffer_load_dwordx4 v155, s[56:59], s50 offen offset:3072 lds
  s_mul_i32 s50, s36, 240306
  s_add_u32 s51, s50, 218460
  s_lshr_b32 s50, s50, 16
  s_lshr_b32 s51, s51, 16
  v_and_b32 v7, 15, v2
  v_max_u32 v7, s50, v7
  v_min_u32 v7, s51, v7
  v_and_or_b32 v7, v2, 16, v7
  s_lshl_b32 s51, s46, 7
  s_add_u32 s51, s51, 8192
  v_lshl_add_u32 v7, v7, 2, s51
  v_add_u32 v159, 0x10000, v157
  s_waitcnt vmcnt(0)
  ds_read_b64_tr_b16 v[192:193], v158 offset:0
  ds_read_b64_tr_b16 v[194:195], v158 offset:1024
  ds_read_b64_tr_b16 v[196:197], v159 offset:0
  ds_read_b64_tr_b16 v[198:199], v159 offset:1024
  ds_read_b64_tr_b16 v[200:201], v158 offset:2048
  ds_read_b64_tr_b16 v[202:203], v158 offset:3072
  ds_read_b64_tr_b16 v[204:205], v159 offset:2048
  ds_read_b64_tr_b16 v[206:207], v159 offset:3072
  s_waitcnt vmcnt(0)
  ds_read_b64_tr_b16 v[208:209], v156 offset:16384
  ds_read_b64_tr_b16 v[210:211], v156 offset:17408
  ds_read_b64_tr_b16 v[212:213], v157 offset:16384
  ds_read_b64_tr_b16 v[214:215], v157 offset:17408
  ds_read_b64_tr_b16 v[216:217], v156 offset:18432
  ds_read_b64_tr_b16 v[218:219], v156 offset:19456
  ds_read_b64_tr_b16 v[220:221], v157 offset:18432
  ds_read_b64_tr_b16 v[222:223], v157 offset:19456
  s_add_u32 s50, s14, 0
  s_add_u32 m0, s69, 0
  s_nop 0
  buffer_load_dwordx4 v152, s[56:59], s50 offen offset:0 lds
  buffer_load_dwordx4 v153, s[56:59], s50 offen offset:1024 lds
  buffer_load_dwordx4 v154, s[56:59], s50 offen offset:2048 lds
  buffer_load_dwordx4 v155, s[56:59], s50 offen offset:3072 lds
  s_add_u32 s50, s14, 32768
  s_add_u32 m0, s69, 49152
  s_nop 0
  buffer_load_dwordx4 v152, s[56:59], s50 offen offset:0 lds
  buffer_load_dwordx4 v153, s[56:59], s50 offen offset:1024 lds
  buffer_load_dwordx4 v154, s[56:59], s50 offen offset:2048 lds
  buffer_load_dwordx4 v155, s[56:59], s50 offen offset:3072 lds
  s_waitcnt vmcnt(0)
  ds_read_b64_tr_b16 v[224:225], v156 offset:32768
  ds_read_b64_tr_b16 v[226:227], v156 offset:33792
  ds_read_b64_tr_b16 v[228:229], v157 offset:32768
  ds_read_b64_tr_b16 v[230:231], v157 offset:33792
  ds_read_b64_tr_b16 v[232:233], v156 offset:34816
  ds_read_b64_tr_b16 v[234:235], v156 offset:35840
  ds_read_b64_tr_b16 v[236:237], v157 offset:34816
  ds_read_b64_tr_b16 v[238:239], v157 offset:35840
  v_mov_b32 v1, s38
  buffer_store_dword v1, off, s[96:99], s49 sc1
  s_waitcnt lgkmcnt(0)
  s_add_u32 s50, s14, 163840
  s_add_u32 m0, s69, 65536
  s_nop 0
  buffer_load_dwordx4 v152, s[56:59], s50 offen offset:0 lds
  buffer_load_dwordx4 v153, s[56:59], s50 offen offset:1024 lds
  buffer_load_dwordx4 v154, s[56:59], s50 offen offset:2048 lds
  buffer_load_dwordx4 v155, s[56:59], s50 offen offset:3072 lds
  s_waitcnt lgkmcnt(0)
  s_add_u32 s50, s14, 196608
  s_add_u32 m0, s69, 16384
  s_nop 0
  buffer_load_dwordx4 v152, s[56:59], s50 offen offset:0 lds
  buffer_load_dwordx4 v153, s[56:59], s50 offen offset:1024 lds
  buffer_load_dwordx4 v154, s[56:59], s50 offen offset:2048 lds
  buffer_load_dwordx4 v155, s[56:59], s50 offen offset:3072 lds
  s_waitcnt lgkmcnt(0)
  s_add_u32 s50, s14, 229376
  s_add_u32 m0, s69, 32768
  s_nop 0
  buffer_load_dwordx4 v152, s[56:59], s50 offen offset:0 lds
  buffer_load_dwordx4 v153, s[56:59], s50 offen offset:1024 lds
  buffer_load_dwordx4 v154, s[56:59], s50 offen offset:2048 lds
  buffer_load_dwordx4 v155, s[56:59], s50 offen offset:3072 lds
  s_lshr_b32 s43, s36, 1
  s_lshl_b32 s43, s43, 5
  s_lshl_b32 s44, s46, 6
  s_add_u32 s43, s43, s44
  v_and_b32 v14, 31, v2
  v_add_u32 v14, s43, v14
  v_lshlrev_b32 v12, 3, v14
  v_lshrrev_b32 v13, 5, v2
  s_and_b32 s43, s36, 1
  s_lshl_b32 s43, s43, 5
  s_lshl_b32 s44, s47, 6
  s_add_u32 s43, s43, s44
  s_lshl_b32 s44, s43, 1
  v_lshlrev_b32 v15, 10, v14
  v_lshl_add_u32 v15, v13, 4, v15
  v_add_u32 v15, s44, v15
  s_lshl_b32 s43, s43, 12
  v_lshlrev_b32 v14, 2, v14
  v_lshl_add_u32 v14, v13, 15, v14
  v_add_u32 v14, s43, v14
  s_lshr_b32 s43, s46, 3
  s_lshl_b32 s43, s43, 8
  s_lshl_b32 s44, s47, 5
  s_add_u32 s43, s43, s44
  s_lshl_b32 s43, s43, 2
  s_add_u32 s43, s43, 12288
  v_and_b32 v10, 31, v2
  v_lshl_add_u32 v13, v10, 2, s43
  s_add_u32 s72, s34, 3145728
  s_addc_u32 s73, s35, 0
  v_add_u32 v12, 65536, v12
  s_mov_b32 s63, 0xffff0000
  global_load_dwordx4 v[16:19], v15, s[8:9]
  global_load_dwordx4 v[20:23], v15, s[8:9] offset:32
  s_waitcnt vmcnt(0)
  ds_read_b64_tr_b16 v[240:241], v158 offset:0
  ds_read_b64_tr_b16 v[242:243], v158 offset:1024
  ds_read_b64_tr_b16 v[244:245], v159 offset:0
  ds_read_b64_tr_b16 v[246:247], v159 offset:1024
  ds_read_b64_tr_b16 v[248:249], v158 offset:2048
  ds_read_b64_tr_b16 v[250:251], v158 offset:3072
  ds_read_b64_tr_b16 v[252:253], v159 offset:2048
  ds_read_b64_tr_b16 v[254:255], v159 offset:3072
  s_waitcnt lgkmcnt(0)
  s_add_u32 s50, s14, 262144
  s_add_u32 m0, s69, 65536
  s_nop 0
  buffer_load_dwordx4 v152, s[56:59], s50 offen offset:0 lds
  buffer_load_dwordx4 v153, s[56:59], s50 offen offset:1024 lds
  buffer_load_dwordx4 v154, s[56:59], s50 offen offset:2048 lds
  buffer_load_dwordx4 v155, s[56:59], s50 offen offset:3072 lds
  s_waitcnt vmcnt(0)
  ds_read_b64_tr_b16 v[120:121], v156 offset:0
  ds_read_b64_tr_b16 v[122:123], v156 offset:1024
  ds_read_b64_tr_b16 v[124:125], v157 offset:0
  ds_read_b64_tr_b16 v[126:127], v157 offset:1024
  ds_read_b64_tr_b16 v[128:129], v156 offset:2048
  ds_read_b64_tr_b16 v[130:131], v156 offset:3072
  ds_read_b64_tr_b16 v[132:133], v157 offset:2048
  ds_read_b64_tr_b16 v[134:135], v157 offset:3072
  s_waitcnt vmcnt(0) lgkmcnt(0)
  s_branch G1JOIN_2
  s_endpgm
S_ROLE:
  s_sub_u32 s37, s2, 256
  s_setprio 3
  s_and_b32 s43, s37, 7
  s_lshr_b32 s44, s37, 3
  s_lshl_b32 s39, s43, 5
  s_add_u32 s39, s39, s44
  s_lshr_b32 s40, s43, 1
  s_lshl_b32 s40, s40, 6
  s_and_b32 s43, s43, 1
  s_lshl_b32 s43, s43, 5
  s_add_u32 s40, s40, s43
  s_add_u32 s40, s40, s44
  s_lshl_b32 s42, s40, 3
  s_lshl_b32 s43, s36, 1
  s_add_u32 s42, s42, s43
  s_lshl_b32 s43, s42, 10
  v_lshl_add_u32 v3, v2, 4, s43
  s_lshr_b32 s45, s36, 1
  s_lshl_b32 s46, s39, 1
  s_add_u32 s46, s46, s45
  s_lshl_b32 s47, s46, 8
  s_and_b32 s48, s36, 1
  s_lshl_b32 s48, s48, 7
  s_add_u32 s47, s47, s48
  v_lshl_add_u32 v9, v2, 1, s47
  s_lshl_b32 s48, s39, 2
  v_mov_b32 v15, 0
  s_waitcnt lgkmcnt(0)
  global_load_dwordx4 v[16:19], v3, s[8:9]
  global_load_dwordx4 v[20:23], v3, s[8:9] offset:1024
  global_load_dword v15, v15, s[34:35] sc1
  global_load_ushort v56, v9, s[10:11]
  global_load_ushort v57, v9, s[12:13]
  global_load_ushort v58, v9, s[14:15]
  global_load_ushort v59, v9, s[16:17]
  s_load_dword s49, s[18:19], s48
  s_load_dword s50, s[20:21], s48
  s_waitcnt vmcnt(4)
  v_mov_b32 v62, 0xffff0000
  v_lshlrev_b32 v24, 16, v16
  v_and_b32 v25, v62, v16
  v_lshlrev_b32 v26, 16, v17
  v_and_b32 v27, v62, v17
  v_lshlrev_b32 v28, 16, v18
  v_and_b32 v29, v62, v18
  v_lshlrev_b32 v30, 16, v19
  v_and_b32 v31, v62, v19
  v_lshlrev_b32 v32, 16, v20
  v_and_b32 v33, v62, v20
  v_lshlrev_b32 v34, 16, v21
  v_and_b32 v35, v62, v21
  v_lshlrev_b32 v36, 16, v22
  v_and_b32 v37, v62, v22
  v_lshlrev_b32 v38, 16, v23
  v_and_b32 v39, v62, v23
  v_add_f32 v40, v24, v25
  v_add_f32 v42, v32, v33
  v_mul_f32 v41, v24, v24
  v_mul_f32 v43, v32, v32
  v_fmac_f32 v41, v25, v25
  v_fmac_f32 v43, v33, v33
  v_add_f32 v40, v40, v26
  v_add_f32 v42, v42, v34
  v_fmac_f32 v41, v26, v26
  v_fmac_f32 v43, v34, v34
  v_add_f32 v40, v40, v27
  v_add_f32 v42, v42, v35
  v_fmac_f32 v41, v27, v27
  v_fmac_f32 v43, v35, v35
  v_add_f32 v40, v40, v28
  v_add_f32 v42, v42, v36
  v_fmac_f32 v41, v28, v28
  v_fmac_f32 v43, v36, v36
  v_add_f32 v40, v40, v29
  v_add_f32 v42, v42, v37
  v_fmac_f32 v41, v29, v29
  v_fmac_f32 v43, v37, v37
  v_add_f32 v40, v40, v30
  v_add_f32 v42, v42, v38
  v_fmac_f32 v41, v30, v30
  v_fmac_f32 v43, v38, v38
  v_add_f32 v40, v40, v31
  v_add_f32 v42, v42, v39
  v_fmac_f32 v41, v31, v31
  v_fmac_f32 v43, v39, v39
  v_readfirstlane_b32 s38, v15
  s_mul_i32 s38, s38, 0x9E3779B1
  s_add_u32 s38, s38, 0x7F4A7C15
  s_and_b32 s38, s38, 0xBFFFBFFF
  v_permlane32_swap_b32 v40, v42
  v_permlane32_swap_b32 v41, v43
  v_add_f32 v40, v40, v42
  v_add_f32 v41, v41, v43
  s_nop 1
  v_permlane16_swap_b32 v40, v41
  v_add_f32 v40, v40, v41
  s_nop 1
  v_add_f32 v40, v40, v40 row_ror:8 row_mask:0xf bank_mask:0xf
  s_nop 1
  v_add_f32 v40, v40, v40 row_ror:4 row_mask:0xf bank_mask:0xf
  s_nop 1
  v_add_f32 v40, v40, v40 row_ror:2 row_mask:0xf bank_mask:0xf
  s_nop 1
  v_add_f32 v40, v40, v40 row_ror:1 row_mask:0xf bank_mask:0xf
  v_mov_b32 v41, v40
  s_nop 1
  v_permlane16_swap_b32 v40, v41
  v_mul_f32 v40, 0x3b000000, v40
  v_mul_f32 v41, 0x3b000000, v41
  v_fma_f32 v41, -v40, v40, v41
  v_max_f32 v41, 0, v41
  v_cvt_pk_bf16_f32 v40, v40, v40
  v_lshlrev_b32 v40, 16, v40
  v_cvt_pk_bf16_f32 v41, v41, v41
  v_lshlrev_b32 v41, 16, v41
  v_add_f32 v41, 0x3727c5ac, v41
  v_cvt_pk_bf16_f32 v41, v41, v41
  v_lshlrev_b32 v41, 16, v41
  v_sqrt_f32 v41, v41
  s_nop 0
  v_cvt_pk_bf16_f32 v41, v41, v41
  v_lshlrev_b32 v41, 16, v41
  v_lshrrev_b32 v66, 16, v40
  v_or_b32 v66, v66, v41
  v_rcp_f32 v41, v41
  v_mov_b32 v42, v40
  v_mov_b32 v67, s38
  v_mov_b32 v43, v41
  v_permlane32_swap_b32 v40, v42
  s_nop 0
  v_permlane32_swap_b32 v41, v43
  v_sub_f32 v24, v24, v40
  v_sub_f32 v25, v25, v40
  v_cvt_pk_bf16_f32 v44, v24, v25
  v_lshlrev_b32 v24, 16, v44
  v_and_b32 v25, v62, v44
  v_mul_f32 v24, v24, v41
  v_mul_f32 v25, v25, v41
  v_cvt_pk_bf16_f32 v44, v24, v25
  v_sub_f32 v32, v32, v42
  v_sub_f32 v33, v33, v42
  v_cvt_pk_bf16_f32 v45, v32, v33
  v_lshlrev_b32 v32, 16, v45
  v_and_b32 v33, v62, v45
  v_mul_f32 v32, v32, v43
  v_mul_f32 v33, v33, v43
  v_cvt_pk_bf16_f32 v45, v32, v33
  v_sub_f32 v26, v26, v40
  v_sub_f32 v27, v27, v40
  v_cvt_pk_bf16_f32 v46, v26, v27
  v_lshlrev_b32 v26, 16, v46
  v_and_b32 v27, v62, v46
  v_mul_f32 v26, v26, v41
  v_mul_f32 v27, v27, v41
  v_cvt_pk_bf16_f32 v46, v26, v27
  v_sub_f32 v34, v34, v42
  v_sub_f32 v35, v35, v42
  v_cvt_pk_bf16_f32 v47, v34, v35
  v_lshlrev_b32 v34, 16, v47
  v_and_b32 v35, v62, v47
  v_mul_f32 v34, v34, v43
  v_mul_f32 v35, v35, v43
  v_cvt_pk_bf16_f32 v47, v34, v35
  v_sub_f32 v28, v28, v40
  v_sub_f32 v29, v29, v40
  v_cvt_pk_bf16_f32 v48, v28, v29
  v_lshlrev_b32 v28, 16, v48
  v_and_b32 v29, v62, v48
  v_mul_f32 v28, v28, v41
  v_mul_f32 v29, v29, v41
  v_cvt_pk_bf16_f32 v48, v28, v29
  v_sub_f32 v36, v36, v42
  v_sub_f32 v37, v37, v42
  v_cvt_pk_bf16_f32 v49, v36, v37
  v_lshlrev_b32 v36, 16, v49
  v_and_b32 v37, v62, v49
  v_mul_f32 v36, v36, v43
  v_mul_f32 v37, v37, v43
  v_cvt_pk_bf16_f32 v49, v36, v37
  v_sub_f32 v30, v30, v40
  v_sub_f32 v31, v31, v40
  v_cvt_pk_bf16_f32 v50, v30, v31
  v_lshlrev_b32 v30, 16, v50
  v_and_b32 v31, v62, v50
  v_mul_f32 v30, v30, v41
  v_mul_f32 v31, v31, v41
  v_cvt_pk_bf16_f32 v50, v30, v31
  v_sub_f32 v38, v38, v42
  v_sub_f32 v39, v39, v42
  v_cvt_pk_bf16_f32 v51, v38, v39
  v_lshlrev_b32 v38, 16, v51
  v_and_b32 v39, v62, v51
  v_mul_f32 v38, v38, v43
  v_mul_f32 v39, v39, v43
  v_cvt_pk_bf16_f32 v51, v38, v39
  v_mul_u32_u24 v60, 144, v2
  s_lshl_b32 s43, s36, 3
  s_add_u32 s43, s43, 70464
  v_add_u32 v60, s43, v60
  ds_write_b64 v60, v[44:45] offset:0
  ds_write_b64 v60, v[46:47] offset:32
  ds_write_b64 v60, v[48:49] offset:64
  ds_write_b64 v60, v[50:51] offset:96
  s_add_u32 s52, s34, 65536
  s_addc_u32 s53, s35, 0
  v_lshrrev_b32 v61, 5, v2
  v_add_u32 v61, s42, v61
  v_lshlrev_b32 v61, 3, v61
  v_and_b32 v63, 31, v2
  v_cmp_eq_u32 vcc, 0, v63
  s_and_saveexec_b64 s[74:75], vcc
  global_store_dwordx2 v61, v[66:67], s[52:53] sc1
  s_mov_b64 exec, s[74:75]
  v_lshrrev_b32 v60, 3, v2
  v_mul_u32_u24 v60, 144, v60
  v_and_b32 v61, 7, v2
  v_lshl_add_u32 v60, v61, 4, v60
  s_mul_i32 s43, s36, 2304
  s_add_u32 s43, s43, 70464
  v_add_u32 v60, s43, v60
  s_waitcnt lgkmcnt(0)
  s_barrier
  ds_read_b128 v[44:47], v60
  ds_read_b128 v[48:51], v60 offset:1152
  s_add_u32 s52, s34, 1048576
  s_addc_u32 s53, s35, 0
  s_lshl_b32 s43, s40, 13
  s_lshl_b32 s44, s36, 11
  s_add_u32 s43, s43, s44
  v_lshl_add_u32 v61, v2, 4, s43
  s_waitcnt lgkmcnt(1)
  global_store_dwordx4 v61, v[44:47], s[52:53] sc1
  s_waitcnt lgkmcnt(0)
  global_store_dwordx4 v61, v[48:51], s[52:53] offset:1024 sc1
  s_setprio 1
  s_waitcnt vmcnt(3) lgkmcnt(0)
  s_lshl_b32 s51, s45, 4
  s_lshr_b32 s49, s49, s51
  s_lshl_b32 s49, s49, 16
  v_mov_b32 v60, s49
  v_mul_f32 v60, 0x3fb8aa3b, v60
  v_exp_f32 v60, v60
  s_nop 0
  v_cvt_pk_bf16_f32 v60, v60, v60
  v_lshlrev_b32 v60, 16, v60
  v_lshlrev_b32 v56, 16, v56
  v_lshlrev_b32 v57, 16, v57
  v_lshlrev_b32 v58, 16, v58
  v_lshlrev_b32 v59, 16, v59
  v_mul_f32 v56, 0x3fb8aa3b, v56
  v_exp_f32 v56, v56
  s_nop 0
  v_cvt_pk_bf16_f32 v56, v56, v56
  v_lshlrev_b32 v56, 16, v56
  v_mul_f32 v56, v56, v60
  v_mul_f32 v57, v57, v60
  v_mul_f32 v56, 0xbfb8aa3b, v56
  v_mul_f32 v57, 0x3e22f983, v57
  v_add_f32 v60, v60, v60
  v_mul_f32 v16, v58, v60
  v_mul_f32 v17, v59, v60
  v_mul_f32 v61, 0x3f800000, v56
  v_mul_f32 v62, 0x3f800000, v57
  v_exp_f32 v61, v61
  v_fract_f32 v62, v62
  v_cos_f32 v63, v62
  v_sin_f32 v62, v62
  v_mul_f32 v20, v61, v63
  v_mul_f32 v21, v61, v62
  v_mul_f32 v61, 0x41000000, v56
  v_mul_f32 v62, 0x41000000, v57
  v_exp_f32 v61, v61
  v_fract_f32 v62, v62
  v_cos_f32 v63, v62
  v_sin_f32 v62, v62
  v_mul_f32 v22, v61, v63
  v_mul_f32 v23, v61, v62
  v_mul_f32 v61, 0x43000000, v56
  v_mul_f32 v62, 0x43000000, v57
  v_exp_f32 v61, v61
  v_fract_f32 v62, v62
  v_cos_f32 v63, v62
  v_sin_f32 v62, v62
  v_mul_f32 v24, v61, v63
  v_mul_f32 v25, v61, v62
  v_mul_f32 v40, v20, v20
  v_mul_f32 v41, v21, v20
  v_fma_f32 v26, -v21, v21, v40
  v_fma_f32 v27, v20, v21, v41
  v_mul_f32 v40, v26, v26
  v_mul_f32 v41, v27, v26
  v_fma_f32 v28, -v27, v27, v40
  v_fma_f32 v29, v26, v27, v41
  v_mul_f32 v40, v26, v28
  v_mul_f32 v41, v27, v28
  v_fma_f32 v30, -v27, v29, v40
  v_fma_f32 v31, v26, v29, v41
  s_mul_i32 s51, s45, 31008
  s_and_b32 s48, s36, 1
  s_lshl_b32 s48, s48, 8
  s_add_u32 s51, s51, s48
  v_lshlrev_b32 v64, 2, v2
  v_add_u32 v64, s51, v64
  v_mov_b32 v32, 1.0
  v_mov_b32 v33, 0
  v_cvt_pk_bf16_f32 v65, v32, v33
  ds_write_b32 v64, v65 offset:0
  v_cvt_pk_bf16_f32 v65, v22, v23
  ds_write_b32 v64, v65 offset:544
  v_mul_f32 v40, v22, v22
  v_mul_f32 v41, v23, v22
  v_fma_f32 v32, -v23, v23, v40
  v_fma_f32 v33, v22, v23, v41
  v_cvt_pk_bf16_f32 v65, v32, v33
  ds_write_b32 v64, v65 offset:1088
  v_mul_f32 v40, v32, v22
  v_mul_f32 v41, v33, v22
  v_fma_f32 v34, -v33, v23, v40
  v_fma_f32 v35, v32, v23, v41
  v_cvt_pk_bf16_f32 v65, v34, v35
  ds_write_b32 v64, v65 offset:1632
  v_mul_f32 v40, v34, v22
  v_mul_f32 v41, v35, v22
  v_fma_f32 v32, -v35, v23, v40
  v_fma_f32 v33, v34, v23, v41
  v_cvt_pk_bf16_f32 v65, v32, v33
  ds_write_b32 v64, v65 offset:2176
  v_mul_f32 v40, v32, v22
  v_mul_f32 v41, v33, v22
  v_fma_f32 v34, -v33, v23, v40
  v_fma_f32 v35, v32, v23, v41
  v_cvt_pk_bf16_f32 v65, v34, v35
  ds_write_b32 v64, v65 offset:2720
  v_mul_f32 v40, v34, v22
  v_mul_f32 v41, v35, v22
  v_fma_f32 v32, -v35, v23, v40
  v_fma_f32 v33, v34, v23, v41
  v_cvt_pk_bf16_f32 v65, v32, v33
  ds_write_b32 v64, v65 offset:3264
  v_mul_f32 v40, v32, v22
  v_mul_f32 v41, v33, v22
  v_fma_f32 v34, -v33, v23, v40
  v_fma_f32 v35, v32, v23, v41
  v_cvt_pk_bf16_f32 v65, v34, v35
  ds_write_b32 v64, v65 offset:3808
  v_mul_f32 v40, v34, v22
  v_mul_f32 v41, v35, v22
  v_fma_f32 v32, -v35, v23, v40
  v_fma_f32 v33, v34, v23, v41
  v_cvt_pk_bf16_f32 v65, v32, v33
  ds_write_b32 v64, v65 offset:4352
  v_mul_f32 v40, v32, v22
  v_mul_f32 v41, v33, v22
  v_fma_f32 v34, -v33, v23, v40
  v_fma_f32 v35, v32, v23, v41
  v_cvt_pk_bf16_f32 v65, v34, v35
  ds_write_b32 v64, v65 offset:4896
  v_mul_f32 v40, v34, v22
  v_mul_f32 v41, v35, v22
  v_fma_f32 v32, -v35, v23, v40
  v_fma_f32 v33, v34, v23, v41
  v_cvt_pk_bf16_f32 v65, v32, v33
  ds_write_b32 v64, v65 offset:5440
  v_mul_f32 v40, v32, v22
  v_mul_f32 v41, v33, v22
  v_fma_f32 v34, -v33, v23, v40
  v_fma_f32 v35, v32, v23, v41
  v_cvt_pk_bf16_f32 v65, v34, v35
  ds_write_b32 v64, v65 offset:5984
  v_mul_f32 v40, v34, v22
  v_mul_f32 v41, v35, v22
  v_fma_f32 v32, -v35, v23, v40
  v_fma_f32 v33, v34, v23, v41
  v_cvt_pk_bf16_f32 v65, v32, v33
  ds_write_b32 v64, v65 offset:6528
  v_mul_f32 v40, v32, v22
  v_mul_f32 v41, v33, v22
  v_fma_f32 v34, -v33, v23, v40
  v_fma_f32 v35, v32, v23, v41
  v_cvt_pk_bf16_f32 v65, v34, v35
  ds_write_b32 v64, v65 offset:7072
  v_mul_f32 v40, v34, v22
  v_mul_f32 v41, v35, v22
  v_fma_f32 v32, -v35, v23, v40
  v_fma_f32 v33, v34, v23, v41
  v_cvt_pk_bf16_f32 v65, v32, v33
  ds_write_b32 v64, v65 offset:7616
  v_mul_f32 v40, v32, v22
  v_mul_f32 v41, v33, v22
  v_fma_f32 v34, -v33, v23, v40
  v_fma_f32 v35, v32, v23, v41
  v_cvt_pk_bf16_f32 v65, v34, v35
  ds_write_b32 v64, v65 offset:8160
  v_cvt_pk_bf16_f32 v66, v16, -v17
  ds_write_b32 v64, v66 offset:8704
  v_mul_f32 v42, v16, v20
  v_mul_f32 v43, v17, v20
  v_fma_f32 v32, -v17, v21, v42
  v_fma_f32 v33, v16, v21, v43
  v_cvt_pk_bf16_f32 v67, v32, -v33
  ds_write_b32 v64, v67 offset:9248
  v_mul_f32 v42, v32, v20
  v_mul_f32 v43, v33, v20
  v_fma_f32 v34, -v33, v21, v42
  v_fma_f32 v35, v32, v21, v43
  v_cvt_pk_bf16_f32 v66, v34, -v35
  ds_write_b32 v64, v66 offset:9792
  v_mul_f32 v42, v34, v20
  v_mul_f32 v43, v35, v20
  v_fma_f32 v32, -v35, v21, v42
  v_fma_f32 v33, v34, v21, v43
  v_cvt_pk_bf16_f32 v67, v32, -v33
  ds_write_b32 v64, v67 offset:10336
  v_mul_f32 v42, v32, v20
  v_mul_f32 v43, v33, v20
  v_fma_f32 v34, -v33, v21, v42
  v_fma_f32 v35, v32, v21, v43
  v_cvt_pk_bf16_f32 v66, v34, -v35
  ds_write_b32 v64, v66 offset:10880
  v_mul_f32 v42, v34, v20
  v_mul_f32 v43, v35, v20
  v_fma_f32 v32, -v35, v21, v42
  v_fma_f32 v33, v34, v21, v43
  v_cvt_pk_bf16_f32 v67, v32, -v33
  ds_write_b32 v64, v67 offset:11424
  v_mul_f32 v42, v32, v20
  v_mul_f32 v43, v33, v20
  v_fma_f32 v34, -v33, v21, v42
  v_fma_f32 v35, v32, v21, v43
  v_cvt_pk_bf16_f32 v66, v34, -v35
  ds_write_b32 v64, v66 offset:11968
  v_mul_f32 v42, v34, v20
  v_mul_f32 v43, v35, v20
  v_fma_f32 v32, -v35, v21, v42
  v_fma_f32 v33, v34, v21, v43
  v_cvt_pk_bf16_f32 v67, v32, -v33
  ds_write_b32 v64, v67 offset:12512
  v_mul_f32 v40, v16, v24
  v_mul_f32 v41, v17, v24
  v_fma_f32 v18, -v17, v25, v40
  v_fma_f32 v19, v16, v25, v41
  v_cvt_pk_bf16_f32 v66, v18, -v19
  ds_write_b32 v64, v66 offset:13056
  v_mul_f32 v42, v18, v20
  v_mul_f32 v43, v19, v20
  v_fma_f32 v32, -v19, v21, v42
  v_fma_f32 v33, v18, v21, v43
  v_cvt_pk_bf16_f32 v67, v32, -v33
  ds_write_b32 v64, v67 offset:13600
  v_mul_f32 v42, v32, v20
  v_mul_f32 v43, v33, v20
  v_fma_f32 v34, -v33, v21, v42
  v_fma_f32 v35, v32, v21, v43
  v_cvt_pk_bf16_f32 v66, v34, -v35
  ds_write_b32 v64, v66 offset:14144
  v_mul_f32 v42, v34, v20
  v_mul_f32 v43, v35, v20
  v_fma_f32 v32, -v35, v21, v42
  v_fma_f32 v33, v34, v21, v43
  v_cvt_pk_bf16_f32 v67, v32, -v33
  ds_write_b32 v64, v67 offset:14688
  v_mul_f32 v42, v32, v20
  v_mul_f32 v43, v33, v20
  v_fma_f32 v34, -v33, v21, v42
  v_fma_f32 v35, v32, v21, v43
  v_cvt_pk_bf16_f32 v66, v34, -v35
  ds_write_b32 v64, v66 offset:15232
  v_mul_f32 v42, v34, v20
  v_mul_f32 v43, v35, v20
  v_fma_f32 v32, -v35, v21, v42
  v_fma_f32 v33, v34, v21, v43
  v_cvt_pk_bf16_f32 v67, v32, -v33
  ds_write_b32 v64, v67 offset:15776
  v_mul_f32 v42, v32, v20
  v_mul_f32 v43, v33, v20
  v_fma_f32 v34, -v33, v21, v42
  v_fma_f32 v35, v32, v21, v43
  v_cvt_pk_bf16_f32 v66, v34, -v35
  ds_write_b32 v64, v66 offset:16320
  v_mul_f32 v42, v34, v20
  v_mul_f32 v43, v35, v20
  v_fma_f32 v32, -v35, v21, v42
  v_fma_f32 v33, v34, v21, v43
  v_cvt_pk_bf16_f32 v67, v32, -v33
  ds_write_b32 v64, v67 offset:16864
  s_waitcnt vmcnt(0)
  s_lshl_b32 s43, s36, 8
  s_add_u32 s43, s43, s40
  s_lshl_b32 s43, s43, 2
  s_add_u32 s43, s43, 4096
  v_mov_b32 v66, s43
  v_mov_b32 v67, s38
  v_cmp_eq_u32 vcc, 0, v2
  s_and_saveexec_b64 s[74:75], vcc
  global_store_dword v66, v67, s[34:35] sc1
  s_mov_b64 exec, s[74:75]
  v_mul_f32 v40, v18, v24
  v_mul_f32 v41, v19, v24
  v_fma_f32 v16, -v19, v25, v40
  v_fma_f32 v17, v18, v25, v41
  v_cvt_pk_bf16_f32 v66, v16, -v17
  ds_write_b32 v64, v66 offset:17408
  v_mul_f32 v42, v16, v26
  v_mul_f32 v43, v17, v26
  v_fma_f32 v32, -v17, v27, v42
  v_fma_f32 v33, v16, v27, v43
  v_cvt_pk_bf16_f32 v67, v32, -v33
  ds_write_b32 v64, v67 offset:17952
  v_mul_f32 v42, v16, v28
  v_mul_f32 v43, v17, v28
  v_fma_f32 v34, -v17, v29, v42
  v_fma_f32 v35, v16, v29, v43
  v_cvt_pk_bf16_f32 v66, v34, -v35
  ds_write_b32 v64, v66 offset:18496
  v_mul_f32 v42, v16, v30
  v_mul_f32 v43, v17, v30
  v_fma_f32 v32, -v17, v31, v42
  v_fma_f32 v33, v16, v31, v43
  v_cvt_pk_bf16_f32 v67, v32, -v33
  ds_write_b32 v64, v67 offset:19040
  v_mul_f32 v40, v16, v24
  v_mul_f32 v41, v17, v24
  v_fma_f32 v18, -v17, v25, v40
  v_fma_f32 v19, v16, v25, v41
  v_cvt_pk_bf16_f32 v66, v18, -v19
  ds_write_b32 v64, v66 offset:19584
  v_mul_f32 v42, v18, v26
  v_mul_f32 v43, v19, v26
  v_fma_f32 v32, -v19, v27, v42
  v_fma_f32 v33, v18, v27, v43
  v_cvt_pk_bf16_f32 v67, v32, -v33
  ds_write_b32 v64, v67 offset:20128
  v_mul_f32 v42, v18, v28
  v_mul_f32 v43, v19, v28
  v_fma_f32 v34, -v19, v29, v42
  v_fma_f32 v35, v18, v29, v43
  v_cvt_pk_bf16_f32 v66, v34, -v35
  ds_write_b32 v64, v66 offset:20672
  v_mul_f32 v42, v18, v30
  v_mul_f32 v43, v19, v30
  v_fma_f32 v32, -v19, v31, v42
  v_fma_f32 v33, v18, v31, v43
  v_cvt_pk_bf16_f32 v67, v32, -v33
  ds_write_b32 v64, v67 offset:21216
  v_mul_f32 v40, v18, v24
  v_mul_f32 v41, v19, v24
  v_fma_f32 v16, -v19, v25, v40
  v_fma_f32 v17, v18, v25, v41
  v_cvt_pk_bf16_f32 v66, v16, -v17
  ds_write_b32 v64, v66 offset:21760
  v_mul_f32 v42, v16, v28
  v_mul_f32 v43, v17, v28
  v_fma_f32 v32, -v17, v29, v42
  v_fma_f32 v33, v16, v29, v43
  v_cvt_pk_bf16_f32 v67, v32, -v33
  ds_write_b32 v64, v67 offset:22304
  v_mul_f32 v40, v16, v24
  v_mul_f32 v41, v17, v24
  v_fma_f32 v18, -v17, v25, v40
  v_fma_f32 v19, v16, v25, v41
  v_cvt_pk_bf16_f32 v66, v18, -v19
  ds_write_b32 v64, v66 offset:22848
  v_mul_f32 v42, v18, v28
  v_mul_f32 v43, v19, v28
  v_fma_f32 v32, -v19, v29, v42
  v_fma_f32 v33, v18, v29, v43
  v_cvt_pk_bf16_f32 v67, v32, -v33
  ds_write_b32 v64, v67 offset:23392
  v_mul_f32 v40, v18, v24
  v_mul_f32 v41, v19, v24
  v_fma_f32 v16, -v19, v25, v40
  v_fma_f32 v17, v18, v25, v41
  v_cvt_pk_bf16_f32 v66, v16, -v17
  ds_write_b32 v64, v66 offset:23936
  v_mul_f32 v42, v16, v28
  v_mul_f32 v43, v17, v28
  v_fma_f32 v32, -v17, v29, v42
  v_fma_f32 v33, v16, v29, v43
  v_cvt_pk_bf16_f32 v67, v32, -v33
  ds_write_b32 v64, v67 offset:24480
  v_mul_f32 v40, v16, v24
  v_mul_f32 v41, v17, v24
  v_fma_f32 v18, -v17, v25, v40
  v_fma_f32 v19, v16, v25, v41
  v_cvt_pk_bf16_f32 v66, v18, -v19
  ds_write_b32 v64, v66 offset:25024
  v_mul_f32 v42, v18, v28
  v_mul_f32 v43, v19, v28
  v_fma_f32 v32, -v19, v29, v42
  v_fma_f32 v33, v18, v29, v43
  v_cvt_pk_bf16_f32 v67, v32, -v33
  ds_write_b32 v64, v67 offset:25568
  v_mul_f32 v40, v18, v24
  v_mul_f32 v41, v19, v24
  v_fma_f32 v16, -v19, v25, v40
  v_fma_f32 v17, v18, v25, v41
  v_cvt_pk_bf16_f32 v66, v16, -v17
  ds_write_b32 v64, v66 offset:26112
  v_mul_f32 v40, v16, v24
  v_mul_f32 v41, v17, v24
  v_fma_f32 v18, -v17, v25, v40
  v_fma_f32 v19, v16, v25, v41
  v_cvt_pk_bf16_f32 v67, v18, -v19
  ds_write_b32 v64, v67 offset:26656
  v_mul_f32 v40, v18, v24
  v_mul_f32 v41, v19, v24
  v_fma_f32 v16, -v19, v25, v40
  v_fma_f32 v17, v18, v25, v41
  v_cvt_pk_bf16_f32 v66, v16, -v17
  ds_write_b32 v64, v66 offset:27200
  v_mul_f32 v40, v16, v24
  v_mul_f32 v41, v17, v24
  v_fma_f32 v18, -v17, v25, v40
  v_fma_f32 v19, v16, v25, v41
  v_cvt_pk_bf16_f32 v67, v18, -v19
  ds_write_b32 v64, v67 offset:27744
  v_mul_f32 v40, v18, v24
  v_mul_f32 v41, v19, v24
  v_fma_f32 v16, -v19, v25, v40
  v_fma_f32 v17, v18, v25, v41
  v_cvt_pk_bf16_f32 v66, v16, -v17
  ds_write_b32 v64, v66 offset:28288
  v_mul_f32 v40, v16, v24
  v_mul_f32 v41, v17, v24
  v_fma_f32 v18, -v17, v25, v40
  v_fma_f32 v19, v16, v25, v41
  v_cvt_pk_bf16_f32 v67, v18, -v19
  ds_write_b32 v64, v67 offset:28832
  v_mul_f32 v40, v18, v24
  v_mul_f32 v41, v19, v24
  v_fma_f32 v16, -v19, v25, v40
  v_fma_f32 v17, v18, v25, v41
  v_cvt_pk_bf16_f32 v66, v16, -v17
  ds_write_b32 v64, v66 offset:29376
  v_mul_f32 v40, v16, v24
  v_mul_f32 v41, v17, v24
  v_fma_f32 v18, -v17, v25, v40
  v_fma_f32 v19, v16, v25, v41
  v_cvt_pk_bf16_f32 v67, v18, -v19
  ds_write_b32 v64, v67 offset:29920
  v_mul_f32 v40, v18, v24
  v_mul_f32 v41, v19, v24
  v_fma_f32 v16, -v19, v25, v40
  v_fma_f32 v17, v18, v25, v41
  v_cvt_pk_bf16_f32 v66, v16, -v17
  ds_write_b32 v64, v66 offset:30464
  v_mov_b32 v65, 0
  v_and_b32 v66, 7, v0
  v_lshlrev_b32 v66, 2, v66
  v_bfe_u32 v67, v0, 3, 1
  v_mul_u32_u24 v67, 4224, v67
  v_add_u32 v66, v66, v67
  ds_write_b32 v66, v65 offset:62016
  s_waitcnt lgkmcnt(0)
  s_barrier
  v_and_b32 v66, 15, v2
  v_lshrrev_b32 v67, 4, v2
  v_mul_u32_u24 v68, 544, v66
  v_lshl_add_u32 v68, v67, 4, v68
  s_mul_i32 s51, s45, 31008
  v_add_u32 v68, s51, v68
  s_and_b32 s48, s36, 1
  s_mul_i32 s48, s48, 17408
  v_add_u32 v69, s48, v68
  ds_read_b128 v[80:83], v68 offset:0
  ds_read_b128 v[84:87], v68 offset:64
  ds_read_b128 v[88:91], v68 offset:128
  ds_read_b128 v[92:95], v68 offset:192
  ds_read_b128 v[96:99], v68 offset:256
  ds_read_b128 v[100:103], v68 offset:320
  ds_read_b128 v[104:107], v68 offset:384
  ds_read_b128 v[108:111], v68 offset:448
  ds_read_b128 v[112:115], v69 offset:8704
  ds_read_b128 v[116:119], v69 offset:8768
  ds_read_b128 v[120:123], v69 offset:8832
  ds_read_b128 v[124:127], v69 offset:8896
  ds_read_b128 v[128:131], v69 offset:8960
  ds_read_b128 v[132:135], v69 offset:9024
  ds_read_b128 v[136:139], v69 offset:9088
  ds_read_b128 v[140:143], v69 offset:9152
  ds_read_b128 v[144:147], v69 offset:17408
  ds_read_b128 v[148:151], v69 offset:17472
  ds_read_b128 v[152:155], v69 offset:17536
  ds_read_b128 v[156:159], v69 offset:17600
  ds_read_b128 v[160:163], v69 offset:17664
  ds_read_b128 v[164:167], v69 offset:17728
  ds_read_b128 v[168:171], v69 offset:17792
  ds_read_b128 v[172:175], v69 offset:17856
  v_mov_b32 v72, 0
  v_mov_b32 v73, 0
  v_mov_b32 v74, 0
  v_mov_b32 v75, 0
  v_mov_b32 v76, 0
  v_mov_b32 v77, 0
  v_mov_b32 v78, 0
  v_mov_b32 v79, 0
  s_waitcnt lgkmcnt(15)
  v_mfma_f32_16x16x32_bf16 v[72:75], v[80:83], v[112:115], v[72:75]
  s_waitcnt lgkmcnt(14)
  v_mfma_f32_16x16x32_bf16 v[72:75], v[84:87], v[116:119], v[72:75]
  s_waitcnt lgkmcnt(13)
  v_mfma_f32_16x16x32_bf16 v[72:75], v[88:91], v[120:123], v[72:75]
  s_waitcnt lgkmcnt(12)
  v_mfma_f32_16x16x32_bf16 v[72:75], v[92:95], v[124:127], v[72:75]
  s_waitcnt lgkmcnt(11)
  v_mfma_f32_16x16x32_bf16 v[72:75], v[96:99], v[128:131], v[72:75]
  s_waitcnt lgkmcnt(10)
  v_mfma_f32_16x16x32_bf16 v[72:75], v[100:103], v[132:135], v[72:75]
  s_waitcnt lgkmcnt(9)
  v_mfma_f32_16x16x32_bf16 v[72:75], v[104:107], v[136:139], v[72:75]
  s_waitcnt lgkmcnt(8)
  v_mfma_f32_16x16x32_bf16 v[72:75], v[108:111], v[140:143], v[72:75]
  s_waitcnt lgkmcnt(7)
  v_mfma_f32_16x16x32_bf16 v[76:79], v[80:83], v[144:147], v[76:79]
  s_waitcnt lgkmcnt(6)
  v_mfma_f32_16x16x32_bf16 v[76:79], v[84:87], v[148:151], v[76:79]
  s_waitcnt lgkmcnt(5)
  v_mfma_f32_16x16x32_bf16 v[76:79], v[88:91], v[152:155], v[76:79]
  s_waitcnt lgkmcnt(4)
  v_mfma_f32_16x16x32_bf16 v[76:79], v[92:95], v[156:159], v[76:79]
  s_waitcnt lgkmcnt(3)
  v_mfma_f32_16x16x32_bf16 v[76:79], v[96:99], v[160:163], v[76:79]
  s_waitcnt lgkmcnt(2)
  v_mfma_f32_16x16x32_bf16 v[76:79], v[100:103], v[164:167], v[76:79]
  s_waitcnt lgkmcnt(1)
  v_mfma_f32_16x16x32_bf16 v[76:79], v[104:107], v[168:171], v[76:79]
  s_waitcnt lgkmcnt(0)
  v_mfma_f32_16x16x32_bf16 v[76:79], v[108:111], v[172:175], v[76:79]
  v_lshrrev_b32 v70, 3, v66
  v_lshlrev_b32 v70, 7, v70
  v_and_b32 v71, 7, v66
  v_add_u32 v70, v70, v71
  v_lshlrev_b32 v71, 7, v66
  v_add_u32 v71, 1024, v71
  s_and_b32 s48, s36, 1
  s_cmp_eq_u32 s48, 0
  s_cselect_b64 vcc, -1, 0
  v_cndmask_b32 v70, v71, v70, vcc
  v_bfe_u32 v71, v66, 2, 1
  v_lshlrev_b32 v71, 7, v71
  v_and_b32 v60, 3, v66
  v_lshl_add_u32 v71, v60, 1, v71
  v_add_u32 v71, 256, v71
  v_bfe_u32 v60, v66, 1, 2
  v_lshlrev_b32 v60, 7, v60
  v_and_b32 v61, 1, v66
  v_lshl_add_u32 v60, v61, 2, v60
  v_add_u32 v60, 512, v60
  v_cmp_gt_u32 vcc, 8, v66
  s_nop 1
  v_cndmask_b32 v71, v60, v71, vcc
  v_lshlrev_b32 v67, 5, v67
  v_add_u32 v70, v70, v67
  v_add_u32 v71, v71, v67
  s_mul_i32 s51, s45, 4224
  s_add_u32 s51, s51, 62048
  v_add_u32 v60, 0, v70
  v_min_u32 v60, 2056, v60
  v_lshl_add_u32 v60, v60, 1, s51
  v_cvt_pk_bf16_f32 v61, v72, v72
  ds_write_b16 v60, v61
  v_add_u32 v60, 8, v70
  v_min_u32 v60, 2056, v60
  v_lshl_add_u32 v60, v60, 1, s51
  v_cvt_pk_bf16_f32 v61, v73, v73
  ds_write_b16 v60, v61
  v_add_u32 v60, 16, v70
  v_min_u32 v60, 2056, v60
  v_lshl_add_u32 v60, v60, 1, s51
  v_cvt_pk_bf16_f32 v61, v74, v74
  ds_write_b16 v60, v61
  v_add_u32 v60, 24, v70
  v_min_u32 v60, 2056, v60
  v_lshl_add_u32 v60, v60, 1, s51
  v_cvt_pk_bf16_f32 v61, v75, v75
  ds_write_b16 v60, v61
  s_cmp_eq_u32 s48, 0
  s_cbranch_scc0 KPSKIP_21
  v_add_u32 v60, 0, v71
  v_lshl_add_u32 v60, v60, 1, s51
  v_cvt_pk_bf16_f32 v61, v76, v76
  ds_write_b16 v60, v61
  v_add_u32 v60, 8, v71
  v_lshl_add_u32 v60, v60, 1, s51
  v_cvt_pk_bf16_f32 v61, v77, v77
  ds_write_b16 v60, v61
  v_add_u32 v60, 16, v71
  v_lshl_add_u32 v60, v60, 1, s51
  v_cvt_pk_bf16_f32 v61, v78, v78
  ds_write_b16 v60, v61
  v_add_u32 v60, 24, v71
  v_lshl_add_u32 v60, v60, 1, s51
  v_cvt_pk_bf16_f32 v61, v79, v79
  ds_write_b16 v60, v61
KPSKIP_21:
  s_waitcnt lgkmcnt(0)
  s_barrier
  s_lshr_b32 s43, s39, 6
  s_lshl_b32 s43, s43, 2
  s_add_u32 s43, s43, s36
  s_lshl_b32 s43, s43, 8
  s_add_u32 s43, s43, 4096
  v_lshl_add_u32 v60, v2, 2, s43
  s_mov_b32 s43, 4000
POLL_22:
  global_load_dword v61, v60, s[34:35] sc1
  s_waitcnt vmcnt(0)
  v_cmp_ne_u32 vcc, s38, v61
  s_cbranch_vccz POLLD_23
  s_sub_u32 s43, s43, 1
  s_cmp_lg_u32 s43, 0
  s_cbranch_scc1 POLL_22
POLLD_23:
  s_add_u32 s52, s34, 1048576
  s_addc_u32 s53, s35, 0
  s_lshl_b32 s51, s36, 19
  s_lshl_b32 s43, s39, 5
  s_add_u32 s51, s51, s43
  v_lshrrev_b32 v60, 1, v2
  v_lshlrev_b32 v60, 13, v60
  v_and_b32 v61, 1, v2
  v_lshl_add_u32 v60, v61, 4, v60
  v_add_u32 v60, s51, v60
  v_add_u32 v61, 0x40000, v60
  global_load_dwordx4 v[16:19], v60, s[52:53] sc1
  global_load_dwordx4 v[20:23], v61, s[52:53] sc1
  s_lshl_b32 s51, s36, 9
  v_lshlrev_b32 v60, 3, v2
  v_add_u32 v60, s51, v60
  v_sub_u32 v61, 2047, v60
  v_subrev_u32 v62, 0, v61
  v_cvt_f32_i32 v62, v62
  v_cvt_pk_bf16_f32 v62, v62, v62
  v_lshlrev_b32 v62, 16, v62
  v_cvt_i32_f32 v62, v62
  v_lshlrev_b32 v80, 1, v62
  v_add_u32 v80, 62048, v80
  v_subrev_u32 v62, 1, v61
  v_cvt_f32_i32 v62, v62
  v_cvt_pk_bf16_f32 v62, v62, v62
  v_lshlrev_b32 v62, 16, v62
  v_cvt_i32_f32 v62, v62
  v_lshlrev_b32 v81, 1, v62
  v_add_u32 v81, 62048, v81
  v_subrev_u32 v62, 2, v61
  v_cvt_f32_i32 v62, v62
  v_cvt_pk_bf16_f32 v62, v62, v62
  v_lshlrev_b32 v62, 16, v62
  v_cvt_i32_f32 v62, v62
  v_lshlrev_b32 v82, 1, v62
  v_add_u32 v82, 62048, v82
  v_subrev_u32 v62, 3, v61
  v_cvt_f32_i32 v62, v62
  v_cvt_pk_bf16_f32 v62, v62, v62
  v_lshlrev_b32 v62, 16, v62
  v_cvt_i32_f32 v62, v62
  v_lshlrev_b32 v83, 1, v62
  v_add_u32 v83, 62048, v83
  v_subrev_u32 v62, 4, v61
  v_cvt_f32_i32 v62, v62
  v_cvt_pk_bf16_f32 v62, v62, v62
  v_lshlrev_b32 v62, 16, v62
  v_cvt_i32_f32 v62, v62
  v_lshlrev_b32 v84, 1, v62
  v_add_u32 v84, 62048, v84
  v_subrev_u32 v62, 5, v61
  v_cvt_f32_i32 v62, v62
  v_cvt_pk_bf16_f32 v62, v62, v62
  v_lshlrev_b32 v62, 16, v62
  v_cvt_i32_f32 v62, v62
  v_lshlrev_b32 v85, 1, v62
  v_add_u32 v85, 62048, v85
  v_subrev_u32 v62, 6, v61
  v_cvt_f32_i32 v62, v62
  v_cvt_pk_bf16_f32 v62, v62, v62
  v_lshlrev_b32 v62, 16, v62
  v_cvt_i32_f32 v62, v62
  v_lshlrev_b32 v86, 1, v62
  v_add_u32 v86, 62048, v86
  v_subrev_u32 v62, 7, v61
  v_cvt_f32_i32 v62, v62
  v_cvt_pk_bf16_f32 v62, v62, v62
  v_lshlrev_b32 v62, 16, v62
  v_cvt_i32_f32 v62, v62
  v_lshlrev_b32 v87, 1, v62
  v_add_u32 v87, 62048, v87
  v_subrev_u32 v62, 8, v61
  v_cvt_f32_i32 v62, v62
  v_cvt_pk_bf16_f32 v62, v62, v62
  v_lshlrev_b32 v62, 16, v62
  v_cvt_i32_f32 v62, v62
  v_lshlrev_b32 v88, 1, v62
  v_add_u32 v88, 62048, v88
  v_subrev_u32 v62, 9, v61
  v_cvt_f32_i32 v62, v62
  v_cvt_pk_bf16_f32 v62, v62, v62
  v_lshlrev_b32 v62, 16, v62
  v_cvt_i32_f32 v62, v62
  v_lshlrev_b32 v89, 1, v62
  v_add_u32 v89, 62048, v89
  v_subrev_u32 v62, 10, v61
  v_cvt_f32_i32 v62, v62
  v_cvt_pk_bf16_f32 v62, v62, v62
  v_lshlrev_b32 v62, 16, v62
  v_cvt_i32_f32 v62, v62
  v_lshlrev_b32 v90, 1, v62
  v_add_u32 v90, 62048, v90
  ds_read_u16 v128, v80 offset:0
  ds_read_u16_d16_hi v129, v81 offset:0
  ds_read_u16 v130, v82 offset:0
  ds_read_u16_d16_hi v131, v83 offset:0
  ds_read_u16 v132, v84 offset:0
  ds_read_u16_d16_hi v133, v85 offset:0
  ds_read_u16 v134, v86 offset:0
  ds_read_u16_d16_hi v135, v87 offset:0
  ds_read_u16 v136, v88 offset:0
  ds_read_u16_d16_hi v137, v89 offset:0
  ds_read_u16 v138, v90 offset:0
  ds_read_u16 v140, v80 offset:4224
  ds_read_u16_d16_hi v141, v81 offset:4224
  ds_read_u16 v142, v82 offset:4224
  ds_read_u16_d16_hi v143, v83 offset:4224
  ds_read_u16 v144, v84 offset:4224
  ds_read_u16_d16_hi v145, v85 offset:4224
  ds_read_u16 v146, v86 offset:4224
  ds_read_u16_d16_hi v147, v87 offset:4224
  ds_read_u16 v148, v88 offset:4224
  ds_read_u16_d16_hi v149, v89 offset:4224
  ds_read_u16 v150, v90 offset:4224
  v_lshlrev_b32 v63, 1, v60
  s_waitcnt lgkmcnt(11)
  v_or_b32 v96, v128, v129
  v_or_b32 v97, v130, v131
  v_or_b32 v98, v132, v133
  v_or_b32 v99, v134, v135
  v_or_b32 v100, v136, v137
  v_mov_b32 v101, v138
  v_alignbit_b32 v112, v97, v96, 16
  v_alignbit_b32 v113, v98, v97, 16
  v_alignbit_b32 v114, v99, v98, 16
  v_alignbit_b32 v115, v100, v99, 16
  v_mov_b32 v116, v97
  v_mov_b32 v117, v98
  v_mov_b32 v118, v99
  v_mov_b32 v119, v100
  v_alignbit_b32 v120, v98, v97, 16
  v_alignbit_b32 v121, v99, v98, 16
  v_alignbit_b32 v122, v100, v99, 16
  v_alignbit_b32 v123, v101, v100, 16
  ds_write_b128 v63, v[96:99] offset:0
  ds_write_b128 v63, v[112:115] offset:4160
  ds_write_b128 v63, v[116:119] offset:8320
  ds_write_b128 v63, v[120:123] offset:12480
  s_waitcnt lgkmcnt(4)
  v_or_b32 v104, v140, v141
  v_or_b32 v105, v142, v143
  v_or_b32 v106, v144, v145
  v_or_b32 v107, v146, v147
  v_or_b32 v108, v148, v149
  v_mov_b32 v109, v150
  v_alignbit_b32 v112, v105, v104, 16
  v_alignbit_b32 v113, v106, v105, 16
  v_alignbit_b32 v114, v107, v106, 16
  v_alignbit_b32 v115, v108, v107, 16
  v_mov_b32 v116, v105
  v_mov_b32 v117, v106
  v_mov_b32 v118, v107
  v_mov_b32 v119, v108
  v_alignbit_b32 v120, v106, v105, 16
  v_alignbit_b32 v121, v107, v106, 16
  v_alignbit_b32 v122, v108, v107, 16
  v_alignbit_b32 v123, v109, v108, 16
  ds_write_b128 v63, v[104:107] offset:16640
  ds_write_b128 v63, v[112:115] offset:20800
  ds_write_b128 v63, v[116:119] offset:24960
  ds_write_b128 v63, v[120:123] offset:29120
  v_mov_b32 v64, 0
  v_mov_b32 v65, 0
  v_mov_b32 v66, 0
  v_mov_b32 v67, 0
  v_lshrrev_b32 v60, 1, v0
  v_and_b32 v60, 7, v60
  v_mul_u32_u24 v60, 4160, v60
  v_and_b32 v61, 1, v0
  v_lshl_add_u32 v60, v61, 4, v60
  ds_write_b128 v60, v[64:67] offset:4096
  v_and_b32 v60, 31, v0
  v_lshlrev_b32 v60, 4, v60
  v_bfe_u32 v61, v0, 5, 1
  v_mul_u32_u24 v61, 4608, v61
  v_add_u32 v60, v60, v61
  ds_write_b128 v60, v[64:67] offset:33280
  s_mov_b32 s54, 0x05040100
  s_mov_b32 s55, 0x07060302
  s_lshl_b32 s51, s36, 10
  v_lshl_add_u32 v61, v2, 3, s51
  s_waitcnt vmcnt(0)
  v_perm_b32 v24, v17, v16, s54
  v_perm_b32 v28, v17, v16, s55
  v_perm_b32 v25, v19, v18, s54
  v_perm_b32 v29, v19, v18, s55
  v_perm_b32 v26, v21, v20, s54
  v_perm_b32 v30, v21, v20, s55
  v_perm_b32 v27, v23, v22, s54
  v_perm_b32 v31, v23, v22, s55
  ds_write_b64 v61, v[24:25] offset:33792
  ds_write_b64 v61, v[26:27] offset:34304
  ds_write_b64 v61, v[28:29] offset:38400
  ds_write_b64 v61, v[30:31] offset:38912
  s_waitcnt lgkmcnt(0)
  s_barrier
  v_and_b32 v60, 15, v2
  v_lshrrev_b32 v61, 4, v2
  v_and_b32 v62, 3, v60
  v_sub_u32 v62, 3, v62
  v_mul_u32_u24 v62, 4160, v62
  v_lshrrev_b32 v63, 2, v60
  v_lshlrev_b32 v63, 3, v63
  v_lshl_add_u32 v63, v61, 4, v63
  v_sub_u32 v62, v62, v63
  s_mul_i32 s51, s45, 16640
  s_and_b32 s48, s36, 1
  s_lshl_b32 s56, s48, 8
  s_sub_u32 s51, s51, s56
  s_add_u32 s51, s51, 328
  v_add_u32 v62, s51, v62
  v_lshlrev_b32 v63, 5, v60
  v_lshlrev_b32 v64, 4, v61
  v_sub_u32 v63, v63, v64
  s_mul_i32 s51, s45, 4608
  s_sub_u32 s51, s51, s56
  s_add_u32 s51, s51, 33616
  v_add_u32 v63, s51, v63
  v_mov_b32 v16, 0
  v_mov_b32 v17, 0
  v_mov_b32 v18, 0
  v_mov_b32 v19, 0
  v_mov_b32 v20, 0
  v_mov_b32 v21, 0
  v_mov_b32 v22, 0
  v_mov_b32 v23, 0
  v_mov_b32 v24, 0
  v_mov_b32 v25, 0
  v_mov_b32 v26, 0
  v_mov_b32 v27, 0
  v_mov_b32 v28, 0
  v_mov_b32 v29, 0
  v_mov_b32 v30, 0
  v_mov_b32 v31, 0
  v_mov_b32 v32, 0
  v_mov_b32 v33, 0
  v_mov_b32 v34, 0
  v_mov_b32 v35, 0
  v_mov_b32 v36, 0
  v_mov_b32 v37, 0
  v_mov_b32 v38, 0
  v_mov_b32 v39, 0
  v_mov_b32 v40, 0
  v_mov_b32 v41, 0
  v_mov_b32 v42, 0
  v_mov_b32 v43, 0
  v_mov_b32 v44, 0
  v_mov_b32 v45, 0
  v_mov_b32 v46, 0
  v_mov_b32 v47, 0
  ds_read_b64 v[64:65], v62 offset:3776
  ds_read_b64 v[66:67], v62 offset:3784
  ds_read_b64 v[68:69], v62 offset:3264
  ds_read_b64 v[70:71], v62 offset:3272
  ds_read_b64 v[72:73], v62 offset:2752
  ds_read_b64 v[74:75], v62 offset:2760
  ds_read_b64 v[76:77], v62 offset:2240
  ds_read_b64 v[78:79], v62 offset:2248
  ds_read_b64 v[80:81], v62 offset:1728
  ds_read_b64 v[82:83], v62 offset:1736
  ds_read_b64 v[84:85], v62 offset:1216
  ds_read_b64 v[86:87], v62 offset:1224
  ds_read_b64 v[88:89], v62 offset:704
  ds_read_b64 v[90:91], v62 offset:712
  ds_read_b64 v[92:93], v62 offset:192
  ds_read_b64 v[94:95], v62 offset:200
  ds_read_b128 v[128:131], v63 offset:192
  ds_read_b128 v[132:135], v63 offset:704
  ds_read_b128 v[136:139], v63 offset:1216
  ds_read_b128 v[140:143], v63 offset:1728
  ds_read_b128 v[144:147], v63 offset:2240
  ds_read_b128 v[148:151], v63 offset:2752
  ds_read_b128 v[152:155], v63 offset:3264
  ds_read_b128 v[156:159], v63 offset:3776
  ds_read_b64 v[96:97], v62 offset:3712
  ds_read_b64 v[98:99], v62 offset:3720
  ds_read_b64 v[100:101], v62 offset:3200
  ds_read_b64 v[102:103], v62 offset:3208
  ds_read_b64 v[104:105], v62 offset:2688
  ds_read_b64 v[106:107], v62 offset:2696
  ds_read_b64 v[108:109], v62 offset:2176
  ds_read_b64 v[110:111], v62 offset:2184
  ds_read_b64 v[112:113], v62 offset:1664
  ds_read_b64 v[114:115], v62 offset:1672
  ds_read_b64 v[116:117], v62 offset:1152
  ds_read_b64 v[118:119], v62 offset:1160
  ds_read_b64 v[120:121], v62 offset:640
  ds_read_b64 v[122:123], v62 offset:648
  ds_read_b64 v[124:125], v62 offset:128
  ds_read_b64 v[126:127], v62 offset:136
  ds_read_b128 v[160:163], v63 offset:128
  ds_read_b128 v[164:167], v63 offset:640
  ds_read_b128 v[168:171], v63 offset:1152
  ds_read_b128 v[172:175], v63 offset:1664
  ds_read_b128 v[176:179], v63 offset:2176
  ds_read_b128 v[180:183], v63 offset:2688
  ds_read_b128 v[184:187], v63 offset:3200
  ds_read_b128 v[188:191], v63 offset:3712
  s_waitcnt lgkmcnt(15)
  v_mfma_f32_16x16x32_bf16 v[16:19], v[64:67], v[128:131], v[16:19]
  v_mfma_f32_16x16x32_bf16 v[20:23], v[64:67], v[132:135], v[20:23]
  v_mfma_f32_16x16x32_bf16 v[24:27], v[64:67], v[136:139], v[24:27]
  v_mfma_f32_16x16x32_bf16 v[28:31], v[64:67], v[140:143], v[28:31]
  v_mfma_f32_16x16x32_bf16 v[32:35], v[64:67], v[144:147], v[32:35]
  v_mfma_f32_16x16x32_bf16 v[36:39], v[64:67], v[148:151], v[36:39]
  v_mfma_f32_16x16x32_bf16 v[40:43], v[64:67], v[152:155], v[40:43]
  v_mfma_f32_16x16x32_bf16 v[44:47], v[64:67], v[156:159], v[44:47]
  v_mfma_f32_16x16x32_bf16 v[20:23], v[68:71], v[128:131], v[20:23]
  v_mfma_f32_16x16x32_bf16 v[24:27], v[68:71], v[132:135], v[24:27]
  v_mfma_f32_16x16x32_bf16 v[28:31], v[68:71], v[136:139], v[28:31]
  v_mfma_f32_16x16x32_bf16 v[32:35], v[68:71], v[140:143], v[32:35]
  v_mfma_f32_16x16x32_bf16 v[36:39], v[68:71], v[144:147], v[36:39]
  v_mfma_f32_16x16x32_bf16 v[40:43], v[68:71], v[148:151], v[40:43]
  v_mfma_f32_16x16x32_bf16 v[44:47], v[68:71], v[152:155], v[44:47]
  v_mfma_f32_16x16x32_bf16 v[24:27], v[72:75], v[128:131], v[24:27]
  v_mfma_f32_16x16x32_bf16 v[28:31], v[72:75], v[132:135], v[28:31]
  v_mfma_f32_16x16x32_bf16 v[32:35], v[72:75], v[136:139], v[32:35]
  v_mfma_f32_16x16x32_bf16 v[36:39], v[72:75], v[140:143], v[36:39]
  v_mfma_f32_16x16x32_bf16 v[40:43], v[72:75], v[144:147], v[40:43]
  v_mfma_f32_16x16x32_bf16 v[44:47], v[72:75], v[148:151], v[44:47]
  v_mfma_f32_16x16x32_bf16 v[28:31], v[76:79], v[128:131], v[28:31]
  v_mfma_f32_16x16x32_bf16 v[32:35], v[76:79], v[132:135], v[32:35]
  v_mfma_f32_16x16x32_bf16 v[36:39], v[76:79], v[136:139], v[36:39]
  v_mfma_f32_16x16x32_bf16 v[40:43], v[76:79], v[140:143], v[40:43]
  v_mfma_f32_16x16x32_bf16 v[44:47], v[76:79], v[144:147], v[44:47]
  v_mfma_f32_16x16x32_bf16 v[32:35], v[80:83], v[128:131], v[32:35]
  v_mfma_f32_16x16x32_bf16 v[36:39], v[80:83], v[132:135], v[36:39]
  v_mfma_f32_16x16x32_bf16 v[40:43], v[80:83], v[136:139], v[40:43]
  v_mfma_f32_16x16x32_bf16 v[44:47], v[80:83], v[140:143], v[44:47]
  v_mfma_f32_16x16x32_bf16 v[36:39], v[84:87], v[128:131], v[36:39]
  v_mfma_f32_16x16x32_bf16 v[40:43], v[84:87], v[132:135], v[40:43]
  v_mfma_f32_16x16x32_bf16 v[44:47], v[84:87], v[136:139], v[44:47]
  v_mfma_f32_16x16x32_bf16 v[40:43], v[88:91], v[128:131], v[40:43]
  v_mfma_f32_16x16x32_bf16 v[44:47], v[88:91], v[132:135], v[44:47]
  v_mfma_f32_16x16x32_bf16 v[44:47], v[92:95], v[128:131], v[44:47]
  ds_read_b64 v[64:65], v62 offset:3648
  ds_read_b64 v[66:67], v62 offset:3656
  ds_read_b64 v[68:69], v62 offset:3136
  ds_read_b64 v[70:71], v62 offset:3144
  ds_read_b64 v[72:73], v62 offset:2624
  ds_read_b64 v[74:75], v62 offset:2632
  ds_read_b64 v[76:77], v62 offset:2112
  ds_read_b64 v[78:79], v62 offset:2120
  ds_read_b64 v[80:81], v62 offset:1600
  ds_read_b64 v[82:83], v62 offset:1608
  ds_read_b64 v[84:85], v62 offset:1088
  ds_read_b64 v[86:87], v62 offset:1096
  ds_read_b64 v[88:89], v62 offset:576
  ds_read_b64 v[90:91], v62 offset:584
  ds_read_b64 v[92:93], v62 offset:64
  ds_read_b64 v[94:95], v62 offset:72
  ds_read_b128 v[128:131], v63 offset:64
  ds_read_b128 v[132:135], v63 offset:576
  ds_read_b128 v[136:139], v63 offset:1088
  ds_read_b128 v[140:143], v63 offset:1600
  ds_read_b128 v[144:147], v63 offset:2112
  ds_read_b128 v[148:151], v63 offset:2624
  ds_read_b128 v[152:155], v63 offset:3136
  ds_read_b128 v[156:159], v63 offset:3648
  s_waitcnt lgkmcnt(15)
  v_mfma_f32_16x16x32_bf16 v[16:19], v[96:99], v[160:163], v[16:19]
  v_mfma_f32_16x16x32_bf16 v[20:23], v[96:99], v[164:167], v[20:23]
  v_mfma_f32_16x16x32_bf16 v[24:27], v[96:99], v[168:171], v[24:27]
  v_mfma_f32_16x16x32_bf16 v[28:31], v[96:99], v[172:175], v[28:31]
  v_mfma_f32_16x16x32_bf16 v[32:35], v[96:99], v[176:179], v[32:35]
  v_mfma_f32_16x16x32_bf16 v[36:39], v[96:99], v[180:183], v[36:39]
  v_mfma_f32_16x16x32_bf16 v[40:43], v[96:99], v[184:187], v[40:43]
  v_mfma_f32_16x16x32_bf16 v[44:47], v[96:99], v[188:191], v[44:47]
  v_mfma_f32_16x16x32_bf16 v[20:23], v[100:103], v[160:163], v[20:23]
  v_mfma_f32_16x16x32_bf16 v[24:27], v[100:103], v[164:167], v[24:27]
  v_mfma_f32_16x16x32_bf16 v[28:31], v[100:103], v[168:171], v[28:31]
  v_mfma_f32_16x16x32_bf16 v[32:35], v[100:103], v[172:175], v[32:35]
  v_mfma_f32_16x16x32_bf16 v[36:39], v[100:103], v[176:179], v[36:39]
  v_mfma_f32_16x16x32_bf16 v[40:43], v[100:103], v[180:183], v[40:43]
  v_mfma_f32_16x16x32_bf16 v[44:47], v[100:103], v[184:187], v[44:47]
  v_mfma_f32_16x16x32_bf16 v[24:27], v[104:107], v[160:163], v[24:27]
  v_mfma_f32_16x16x32_bf16 v[28:31], v[104:107], v[164:167], v[28:31]
  v_mfma_f32_16x16x32_bf16 v[32:35], v[104:107], v[168:171], v[32:35]
  v_mfma_f32_16x16x32_bf16 v[36:39], v[104:107], v[172:175], v[36:39]
  v_mfma_f32_16x16x32_bf16 v[40:43], v[104:107], v[176:179], v[40:43]
  v_mfma_f32_16x16x32_bf16 v[44:47], v[104:107], v[180:183], v[44:47]
  v_mfma_f32_16x16x32_bf16 v[28:31], v[108:111], v[160:163], v[28:31]
  v_mfma_f32_16x16x32_bf16 v[32:35], v[108:111], v[164:167], v[32:35]
  v_mfma_f32_16x16x32_bf16 v[36:39], v[108:111], v[168:171], v[36:39]
  v_mfma_f32_16x16x32_bf16 v[40:43], v[108:111], v[172:175], v[40:43]
  v_mfma_f32_16x16x32_bf16 v[44:47], v[108:111], v[176:179], v[44:47]
  v_mfma_f32_16x16x32_bf16 v[32:35], v[112:115], v[160:163], v[32:35]
  v_mfma_f32_16x16x32_bf16 v[36:39], v[112:115], v[164:167], v[36:39]
  v_mfma_f32_16x16x32_bf16 v[40:43], v[112:115], v[168:171], v[40:43]
  v_mfma_f32_16x16x32_bf16 v[44:47], v[112:115], v[172:175], v[44:47]
  v_mfma_f32_16x16x32_bf16 v[36:39], v[116:119], v[160:163], v[36:39]
  v_mfma_f32_16x16x32_bf16 v[40:43], v[116:119], v[164:167], v[40:43]
  v_mfma_f32_16x16x32_bf16 v[44:47], v[116:119], v[168:171], v[44:47]
  v_mfma_f32_16x16x32_bf16 v[40:43], v[120:123], v[160:163], v[40:43]
  v_mfma_f32_16x16x32_bf16 v[44:47], v[120:123], v[164:167], v[44:47]
  v_mfma_f32_16x16x32_bf16 v[44:47], v[124:127], v[160:163], v[44:47]
  ds_read_b64 v[96:97], v62 offset:3584
  ds_read_b64 v[98:99], v62 offset:3592
  ds_read_b64 v[100:101], v62 offset:3072
  ds_read_b64 v[102:103], v62 offset:3080
  ds_read_b64 v[104:105], v62 offset:2560
  ds_read_b64 v[106:107], v62 offset:2568
  ds_read_b64 v[108:109], v62 offset:2048
  ds_read_b64 v[110:111], v62 offset:2056
  ds_read_b64 v[112:113], v62 offset:1536
  ds_read_b64 v[114:115], v62 offset:1544
  ds_read_b64 v[116:117], v62 offset:1024
  ds_read_b64 v[118:119], v62 offset:1032
  ds_read_b64 v[120:121], v62 offset:512
  ds_read_b64 v[122:123], v62 offset:520
  ds_read_b64 v[124:125], v62 offset:0
  ds_read_b64 v[126:127], v62 offset:8
  ds_read_b128 v[160:163], v63 offset:0
  ds_read_b128 v[164:167], v63 offset:512
  ds_read_b128 v[168:171], v63 offset:1024
  ds_read_b128 v[172:175], v63 offset:1536
  ds_read_b128 v[176:179], v63 offset:2048
  ds_read_b128 v[180:183], v63 offset:2560
  ds_read_b128 v[184:187], v63 offset:3072
  ds_read_b128 v[188:191], v63 offset:3584
  s_waitcnt lgkmcnt(15)
  v_mfma_f32_16x16x32_bf16 v[16:19], v[64:67], v[128:131], v[16:19]
  v_mfma_f32_16x16x32_bf16 v[20:23], v[64:67], v[132:135], v[20:23]
  v_mfma_f32_16x16x32_bf16 v[24:27], v[64:67], v[136:139], v[24:27]
  v_mfma_f32_16x16x32_bf16 v[28:31], v[64:67], v[140:143], v[28:31]
  v_mfma_f32_16x16x32_bf16 v[32:35], v[64:67], v[144:147], v[32:35]
  v_mfma_f32_16x16x32_bf16 v[36:39], v[64:67], v[148:151], v[36:39]
  v_mfma_f32_16x16x32_bf16 v[40:43], v[64:67], v[152:155], v[40:43]
  v_mfma_f32_16x16x32_bf16 v[44:47], v[64:67], v[156:159], v[44:47]
  v_mfma_f32_16x16x32_bf16 v[20:23], v[68:71], v[128:131], v[20:23]
  v_mfma_f32_16x16x32_bf16 v[24:27], v[68:71], v[132:135], v[24:27]
  v_mfma_f32_16x16x32_bf16 v[28:31], v[68:71], v[136:139], v[28:31]
  v_mfma_f32_16x16x32_bf16 v[32:35], v[68:71], v[140:143], v[32:35]
  v_mfma_f32_16x16x32_bf16 v[36:39], v[68:71], v[144:147], v[36:39]
  v_mfma_f32_16x16x32_bf16 v[40:43], v[68:71], v[148:151], v[40:43]
  v_mfma_f32_16x16x32_bf16 v[44:47], v[68:71], v[152:155], v[44:47]
  v_mfma_f32_16x16x32_bf16 v[24:27], v[72:75], v[128:131], v[24:27]
  v_mfma_f32_16x16x32_bf16 v[28:31], v[72:75], v[132:135], v[28:31]
  v_mfma_f32_16x16x32_bf16 v[32:35], v[72:75], v[136:139], v[32:35]
  v_mfma_f32_16x16x32_bf16 v[36:39], v[72:75], v[140:143], v[36:39]
  v_mfma_f32_16x16x32_bf16 v[40:43], v[72:75], v[144:147], v[40:43]
  v_mfma_f32_16x16x32_bf16 v[44:47], v[72:75], v[148:151], v[44:47]
  v_mfma_f32_16x16x32_bf16 v[28:31], v[76:79], v[128:131], v[28:31]
  v_mfma_f32_16x16x32_bf16 v[32:35], v[76:79], v[132:135], v[32:35]
  v_mfma_f32_16x16x32_bf16 v[36:39], v[76:79], v[136:139], v[36:39]
  v_mfma_f32_16x16x32_bf16 v[40:43], v[76:79], v[140:143], v[40:43]
  v_mfma_f32_16x16x32_bf16 v[44:47], v[76:79], v[144:147], v[44:47]
  v_mfma_f32_16x16x32_bf16 v[32:35], v[80:83], v[128:131], v[32:35]
  v_mfma_f32_16x16x32_bf16 v[36:39], v[80:83], v[132:135], v[36:39]
  v_mfma_f32_16x16x32_bf16 v[40:43], v[80:83], v[136:139], v[40:43]
  v_mfma_f32_16x16x32_bf16 v[44:47], v[80:83], v[140:143], v[44:47]
  v_mfma_f32_16x16x32_bf16 v[36:39], v[84:87], v[128:131], v[36:39]
  v_mfma_f32_16x16x32_bf16 v[40:43], v[84:87], v[132:135], v[40:43]
  v_mfma_f32_16x16x32_bf16 v[44:47], v[84:87], v[136:139], v[44:47]
  v_mfma_f32_16x16x32_bf16 v[40:43], v[88:91], v[128:131], v[40:43]
  v_mfma_f32_16x16x32_bf16 v[44:47], v[88:91], v[132:135], v[44:47]
  v_mfma_f32_16x16x32_bf16 v[44:47], v[92:95], v[128:131], v[44:47]
  s_waitcnt lgkmcnt(0)
  v_mfma_f32_16x16x32_bf16 v[16:19], v[96:99], v[160:163], v[16:19]
  v_mfma_f32_16x16x32_bf16 v[20:23], v[96:99], v[164:167], v[20:23]
  v_mfma_f32_16x16x32_bf16 v[24:27], v[96:99], v[168:171], v[24:27]
  v_mfma_f32_16x16x32_bf16 v[28:31], v[96:99], v[172:175], v[28:31]
  v_mfma_f32_16x16x32_bf16 v[32:35], v[96:99], v[176:179], v[32:35]
  v_mfma_f32_16x16x32_bf16 v[36:39], v[96:99], v[180:183], v[36:39]
  v_mfma_f32_16x16x32_bf16 v[40:43], v[96:99], v[184:187], v[40:43]
  v_mfma_f32_16x16x32_bf16 v[44:47], v[96:99], v[188:191], v[44:47]
  v_mfma_f32_16x16x32_bf16 v[20:23], v[100:103], v[160:163], v[20:23]
  v_mfma_f32_16x16x32_bf16 v[24:27], v[100:103], v[164:167], v[24:27]
  v_mfma_f32_16x16x32_bf16 v[28:31], v[100:103], v[168:171], v[28:31]
  v_mfma_f32_16x16x32_bf16 v[32:35], v[100:103], v[172:175], v[32:35]
  v_mfma_f32_16x16x32_bf16 v[36:39], v[100:103], v[176:179], v[36:39]
  v_mfma_f32_16x16x32_bf16 v[40:43], v[100:103], v[180:183], v[40:43]
  v_mfma_f32_16x16x32_bf16 v[44:47], v[100:103], v[184:187], v[44:47]
  v_mfma_f32_16x16x32_bf16 v[24:27], v[104:107], v[160:163], v[24:27]
  v_mfma_f32_16x16x32_bf16 v[28:31], v[104:107], v[164:167], v[28:31]
  v_mfma_f32_16x16x32_bf16 v[32:35], v[104:107], v[168:171], v[32:35]
  v_mfma_f32_16x16x32_bf16 v[36:39], v[104:107], v[172:175], v[36:39]
  v_mfma_f32_16x16x32_bf16 v[40:43], v[104:107], v[176:179], v[40:43]
  v_mfma_f32_16x16x32_bf16 v[44:47], v[104:107], v[180:183], v[44:47]
  v_mfma_f32_16x16x32_bf16 v[28:31], v[108:111], v[160:163], v[28:31]
  v_mfma_f32_16x16x32_bf16 v[32:35], v[108:111], v[164:167], v[32:35]
  v_mfma_f32_16x16x32_bf16 v[36:39], v[108:111], v[168:171], v[36:39]
  v_mfma_f32_16x16x32_bf16 v[40:43], v[108:111], v[172:175], v[40:43]
  v_mfma_f32_16x16x32_bf16 v[44:47], v[108:111], v[176:179], v[44:47]
  v_mfma_f32_16x16x32_bf16 v[32:35], v[112:115], v[160:163], v[32:35]
  v_mfma_f32_16x16x32_bf16 v[36:39], v[112:115], v[164:167], v[36:39]
  v_mfma_f32_16x16x32_bf16 v[40:43], v[112:115], v[168:171], v[40:43]
  v_mfma_f32_16x16x32_bf16 v[44:47], v[112:115], v[172:175], v[44:47]
  v_mfma_f32_16x16x32_bf16 v[36:39], v[116:119], v[160:163], v[36:39]
  v_mfma_f32_16x16x32_bf16 v[40:43], v[116:119], v[164:167], v[40:43]
  v_mfma_f32_16x16x32_bf16 v[44:47], v[116:119], v[168:171], v[44:47]
  v_mfma_f32_16x16x32_bf16 v[40:43], v[120:123], v[160:163], v[40:43]
  v_mfma_f32_16x16x32_bf16 v[44:47], v[120:123], v[164:167], v[44:47]
  v_mfma_f32_16x16x32_bf16 v[44:47], v[124:127], v[160:163], v[44:47]
  s_lshl_b32 s51, s36, 13
  v_lshlrev_b32 v60, 4, v2
  v_add_u32 v61, s51, v60
  ds_write_b128 v61, v[16:19] offset:42496
  ds_write_b128 v61, v[20:23] offset:43520
  ds_write_b128 v61, v[24:27] offset:44544
  ds_write_b128 v61, v[28:31] offset:45568
  ds_write_b128 v61, v[32:35] offset:46592
  ds_write_b128 v61, v[36:39] offset:47616
  ds_write_b128 v61, v[40:43] offset:48640
  ds_write_b128 v61, v[44:47] offset:49664
  s_waitcnt lgkmcnt(0)
  s_barrier
  s_lshl_b32 s51, s36, 11
  s_add_u32 s51, s51, 42496
  v_add_u32 v61, s51, v60
  ds_read_b128 v[64:67], v61 offset:0
  ds_read_b128 v[68:71], v61 offset:8192
  ds_read_b128 v[72:75], v61 offset:16384
  ds_read_b128 v[76:79], v61 offset:24576
  ds_read_b128 v[80:83], v61 offset:1024
  ds_read_b128 v[84:87], v61 offset:9216
  ds_read_b128 v[88:91], v61 offset:17408
  ds_read_b128 v[92:95], v61 offset:25600
  v_and_b32 v62, 15, v2
  v_lshrrev_b32 v63, 4, v2
  v_lshlrev_b32 v62, 5, v62
  v_lshl_add_u32 v62, v63, 3, v62
  s_lshl_b32 s51, s36, 10
  v_add_u32 v62, s51, v62
  ds_read_b64 v[96:97], v62 offset:33792
  ds_read_b64 v[98:99], v62 offset:38400
  ds_read_b64 v[100:101], v62 offset:34304
  ds_read_b64 v[102:103], v62 offset:38912
  s_lshl_b32 s56, s50, 16
  s_and_b32 s57, s50, 0xffff0000
  v_mov_b32 v59, 0xffff0000
  s_waitcnt lgkmcnt(0)
  s_add_u32 s52, s34, 3145728
  s_addc_u32 s53, s35, 0
  v_add_f32 v64, v64, v68
  v_add_f32 v65, v65, v69
  v_add_f32 v66, v66, v70
  v_add_f32 v67, v67, v71
  v_lshlrev_b32 v58, 16, v96
  v_mul_f32 v58, s56, v58
  v_cvt_pk_bf16_f32 v57, v64, v58
  v_lshlrev_b32 v58, 16, v57
  v_and_b32 v57, v59, v57
  v_add_f32 v64, v58, v57
  v_and_b32 v58, v59, v96
  v_mul_f32 v58, s56, v58
  v_cvt_pk_bf16_f32 v57, v65, v58
  v_lshlrev_b32 v58, 16, v57
  v_and_b32 v57, v59, v57
  v_add_f32 v65, v58, v57
  v_lshlrev_b32 v58, 16, v97
  v_mul_f32 v58, s56, v58
  v_cvt_pk_bf16_f32 v57, v66, v58
  v_lshlrev_b32 v58, 16, v57
  v_and_b32 v57, v59, v57
  v_add_f32 v66, v58, v57
  v_and_b32 v58, v59, v97
  v_mul_f32 v58, s56, v58
  v_cvt_pk_bf16_f32 v57, v67, v58
  v_lshlrev_b32 v58, 16, v57
  v_and_b32 v57, v59, v57
  v_add_f32 v67, v58, v57
  v_add_f32 v72, v72, v76
  v_add_f32 v73, v73, v77
  v_add_f32 v74, v74, v78
  v_add_f32 v75, v75, v79
  v_lshlrev_b32 v58, 16, v98
  v_mul_f32 v58, s57, v58
  v_cvt_pk_bf16_f32 v57, v72, v58
  v_lshlrev_b32 v58, 16, v57
  v_and_b32 v57, v59, v57
  v_add_f32 v72, v58, v57
  v_and_b32 v58, v59, v98
  v_mul_f32 v58, s57, v58
  v_cvt_pk_bf16_f32 v57, v73, v58
  v_lshlrev_b32 v58, 16, v57
  v_and_b32 v57, v59, v57
  v_add_f32 v73, v58, v57
  v_lshlrev_b32 v58, 16, v99
  v_mul_f32 v58, s57, v58
  v_cvt_pk_bf16_f32 v57, v74, v58
  v_lshlrev_b32 v58, 16, v57
  v_and_b32 v57, v59, v57
  v_add_f32 v74, v58, v57
  v_and_b32 v58, v59, v99
  v_mul_f32 v58, s57, v58
  v_cvt_pk_bf16_f32 v57, v75, v58
  v_lshlrev_b32 v58, 16, v57
  v_and_b32 v57, v59, v57
  v_add_f32 v75, v58, v57
  v_cvt_pk_bf16_f32 v104, v64, v72
  v_cvt_pk_bf16_f32 v105, v65, v73
  v_cvt_pk_bf16_f32 v106, v66, v74
  v_cvt_pk_bf16_f32 v107, v67, v75
  v_add_f32 v80, v80, v84
  v_add_f32 v81, v81, v85
  v_add_f32 v82, v82, v86
  v_add_f32 v83, v83, v87
  v_lshlrev_b32 v58, 16, v100
  v_mul_f32 v58, s56, v58
  v_cvt_pk_bf16_f32 v57, v80, v58
  v_lshlrev_b32 v58, 16, v57
  v_and_b32 v57, v59, v57
  v_add_f32 v80, v58, v57
  v_and_b32 v58, v59, v100
  v_mul_f32 v58, s56, v58
  v_cvt_pk_bf16_f32 v57, v81, v58
  v_lshlrev_b32 v58, 16, v57
  v_and_b32 v57, v59, v57
  v_add_f32 v81, v58, v57
  v_lshlrev_b32 v58, 16, v101
  v_mul_f32 v58, s56, v58
  v_cvt_pk_bf16_f32 v57, v82, v58
  v_lshlrev_b32 v58, 16, v57
  v_and_b32 v57, v59, v57
  v_add_f32 v82, v58, v57
  v_and_b32 v58, v59, v101
  v_mul_f32 v58, s56, v58
  v_cvt_pk_bf16_f32 v57, v83, v58
  v_lshlrev_b32 v58, 16, v57
  v_and_b32 v57, v59, v57
  v_add_f32 v83, v58, v57
  v_add_f32 v88, v88, v92
  v_add_f32 v89, v89, v93
  v_add_f32 v90, v90, v94
  v_add_f32 v91, v91, v95
  v_lshlrev_b32 v58, 16, v102
  v_mul_f32 v58, s57, v58
  v_cvt_pk_bf16_f32 v57, v88, v58
  v_lshlrev_b32 v58, 16, v57
  v_and_b32 v57, v59, v57
  v_add_f32 v88, v58, v57
  v_and_b32 v58, v59, v102
  v_mul_f32 v58, s57, v58
  v_cvt_pk_bf16_f32 v57, v89, v58
  v_lshlrev_b32 v58, 16, v57
  v_and_b32 v57, v59, v57
  v_add_f32 v89, v58, v57
  v_lshlrev_b32 v58, 16, v103
  v_mul_f32 v58, s57, v58
  v_cvt_pk_bf16_f32 v57, v90, v58
  v_lshlrev_b32 v58, 16, v57
  v_and_b32 v57, v59, v57
  v_add_f32 v90, v58, v57
  v_and_b32 v58, v59, v103
  v_mul_f32 v58, s57, v58
  v_cvt_pk_bf16_f32 v57, v91, v58
  v_lshlrev_b32 v58, 16, v57
  v_and_b32 v57, v59, v57
  v_add_f32 v91, v58, v57
  v_cvt_pk_bf16_f32 v108, v80, v88
  v_cvt_pk_bf16_f32 v109, v81, v89
  v_cvt_pk_bf16_f32 v110, v82, v90
  v_cvt_pk_bf16_f32 v111, v83, v91
  v_and_b32 v62, 15, v2
  v_lshrrev_b32 v63, 4, v2
  v_lshlrev_b32 v62, 6, v62
  v_lshl_add_u32 v62, v63, 4, v62
  s_lshl_b32 s51, s39, 13
  s_lshl_b32 s48, s36, 11
  s_add_u32 s51, s51, s48
  v_add_u32 v62, s51, v62
  global_store_dwordx4 v62, v[104:107], s[52:53] sc1
  global_store_dwordx4 v62, v[108:111], s[52:53] offset:1024 sc1
  s_waitcnt vmcnt(0)
  s_lshl_b32 s43, s36, 8
  s_add_u32 s43, s43, s39
  s_lshl_b32 s43, s43, 2
  s_add_u32 s43, s43, 12288
  v_mov_b32 v60, s43
  v_mov_b32 v61, s38
  v_cmp_eq_u32 vcc, 0, v2
  s_and_saveexec_b64 s[74:75], vcc
  global_store_dword v60, v61, s[34:35] sc1
  s_mov_b64 exec, s[74:75]
  s_or_b32 s43, s37, s36
  s_cmp_lg_u32 s43, 0
  s_cbranch_scc1 NOEP_24
  v_lshlrev_b32 v60, 4, v2
  v_add_u32 v60, 4096, v60
  v_add_u32 v61, 4096, v60
  s_mov_b32 s43, 4000
EPL_25:
  global_load_dwordx4 v[64:67], v60, s[34:35] offset:0 sc1
  global_load_dwordx4 v[68:71], v60, s[34:35] offset:1024 sc1
  global_load_dwordx4 v[72:75], v60, s[34:35] offset:2048 sc1
  global_load_dwordx4 v[76:79], v60, s[34:35] offset:3072 sc1
  global_load_dwordx4 v[80:83], v61, s[34:35] offset:0 sc1
  global_load_dwordx4 v[84:87], v61, s[34:35] offset:1024 sc1
  global_load_dwordx4 v[88:91], v61, s[34:35] offset:2048 sc1
  global_load_dwordx4 v[92:95], v61, s[34:35] offset:3072 sc1
  s_waitcnt vmcnt(0)
  v_mov_b32 v62, 0
  v_xor_b32 v64, s38, v64
  v_or_b32 v62, v62, v64
  v_xor_b32 v65, s38, v65
  v_or_b32 v62, v62, v65
  v_xor_b32 v66, s38, v66
  v_or_b32 v62, v62, v66
  v_xor_b32 v67, s38, v67
  v_or_b32 v62, v62, v67
  v_xor_b32 v68, s38, v68
  v_or_b32 v62, v62, v68
  v_xor_b32 v69, s38, v69
  v_or_b32 v62, v62, v69
  v_xor_b32 v70, s38, v70
  v_or_b32 v62, v62, v70
  v_xor_b32 v71, s38, v71
  v_or_b32 v62, v62, v71
  v_xor_b32 v72, s38, v72
  v_or_b32 v62, v62, v72
  v_xor_b32 v73, s38, v73
  v_or_b32 v62, v62, v73
  v_xor_b32 v74, s38, v74
  v_or_b32 v62, v62, v74
  v_xor_b32 v75, s38, v75
  v_or_b32 v62, v62, v75
  v_xor_b32 v76, s38, v76
  v_or_b32 v62, v62, v76
  v_xor_b32 v77, s38, v77
  v_or_b32 v62, v62, v77
  v_xor_b32 v78, s38, v78
  v_or_b32 v62, v62, v78
  v_xor_b32 v79, s38, v79
  v_or_b32 v62, v62, v79
  v_xor_b32 v80, s38, v80
  v_or_b32 v62, v62, v80
  v_xor_b32 v81, s38, v81
  v_or_b32 v62, v62, v81
  v_xor_b32 v82, s38, v82
  v_or_b32 v62, v62, v82
  v_xor_b32 v83, s38, v83
  v_or_b32 v62, v62, v83
  v_xor_b32 v84, s38, v84
  v_or_b32 v62, v62, v84
  v_xor_b32 v85, s38, v85
  v_or_b32 v62, v62, v85
  v_xor_b32 v86, s38, v86
  v_or_b32 v62, v62, v86
  v_xor_b32 v87, s38, v87
  v_or_b32 v62, v62, v87
  v_xor_b32 v88, s38, v88
  v_or_b32 v62, v62, v88
  v_xor_b32 v89, s38, v89
  v_or_b32 v62, v62, v89
  v_xor_b32 v90, s38, v90
  v_or_b32 v62, v62, v90
  v_xor_b32 v91, s38, v91
  v_or_b32 v62, v62, v91
  v_xor_b32 v92, s38, v92
  v_or_b32 v62, v62, v92
  v_xor_b32 v93, s38, v93
  v_or_b32 v62, v62, v93
  v_xor_b32 v94, s38, v94
  v_or_b32 v62, v62, v94
  v_xor_b32 v95, s38, v95
  v_or_b32 v62, v62, v95
  v_cmp_ne_u32 vcc, 0, v62
  s_cbranch_vccz EPD_26
  s_sub_u32 s43, s43, 1
  s_cmp_lg_u32 s43, 0
  s_cbranch_scc1 EPL_25
EPD_26:
  v_mov_b32 v60, 0
  v_mov_b32 v61, s38
  v_cmp_eq_u32 vcc, 0, v2
  s_and_saveexec_b64 s[74:75], vcc
  global_store_dword v60, v61, s[34:35] sc1
  s_mov_b64 exec, s[74:75]
NOEP_24:
  s_endpgm
.section .rodata,"a"
.p2align 6
.amdhsa_kernel parallel_sum__ssm_conv_s4d__glu_gated_bilinear__prompt_kernel
  .amdhsa_next_free_vgpr 256
  .amdhsa_next_free_sgpr 102
  .amdhsa_accum_offset 256
  .amdhsa_group_segment_fixed_size 0
  .amdhsa_kernarg_size 112
  .amdhsa_user_sgpr_count 2
  .amdhsa_user_sgpr_kernarg_segment_ptr 1
  .amdhsa_system_sgpr_workgroup_id_x 1
  .amdhsa_float_denorm_mode_32 3
  .amdhsa_float_denorm_mode_16_64 3
.end_amdhsa_kernel
```
